```python
import torch

def _softmax(x, axis=-1):
    return torch.softmax(x, dim=axis)
def _gelu(x):
    return torch.nn.functional.gelu(x, approximate="tanh")
def _silu(x):
    return torch.nn.functional.silu(x)
def _sigmoid(x):
    return torch.sigmoid(x)
def _layernorm(x, axis=-1, eps=1e-5):
    m = x.mean(dim=axis, keepdim=True)
    v = x.var(dim=axis, keepdim=True, unbiased=False)
    return (x - m) / torch.sqrt(v + eps)
def _scatter_add(tgt, idx, src, axis=0):
    return tgt.clone().index_add_(axis, idx, src)
def _segment_sum(src, seg, n):
    out = torch.zeros((n,) + src.shape[1:], dtype=src.dtype)
    return out.index_add_(0, seg, src)
def _pad(x, pw):
    flat = tuple(v for pair in reversed(pw) for v in pair)
    return torch.nn.functional.pad(x, flat)

kernel_name = 'recurrent_scan__gqa_block_cached__geglu_ffn__decode'

def setup_inputs():

    _w = (lambda a: (lambda t: t.to(torch.bfloat16) if t.is_floating_point() else t)(torch.as_tensor(a)))
    def _A_setup():
        B, Sq, D = 2, 1, 576
        Hq, Hkv, Sk, Dh = 32, 16, 32768, 128
        assert Hq % Hkv == 0, (Hq, Hkv)
        return {
            "x": _w((lambda *s: torch.randn(*s, dtype=torch.bfloat16) * 0.05)(B, Sq, D)),
            "k_cache": _w((lambda *s: torch.randn(*s, dtype=torch.bfloat16) * 1.6)(B, Hkv, Sk, Dh)),
            "v_cache": _w((lambda *s: torch.randn(*s, dtype=torch.bfloat16) * 0.2)(B, Hkv, Sk, Dh)),
            "wq": _w((lambda *s: torch.randn(*s, dtype=torch.bfloat16) * 1.6)(D, Hq * Dh) * (D ** -0.5)),
            "wo": _w((lambda *s: torch.randn(*s, dtype=torch.bfloat16) * 0.2)(Hq * Dh, D) * ((Hq * Dh) ** -0.5)),
        }
    _A_in = _A_setup()

    def _B_setup():
        B, S, D, F = 2, 1, 576, 4608
        return {
            "x": _w((lambda *s: torch.randn(*s, dtype=torch.bfloat16) * 0.05)(B, S, D)),
            "w_gate": _w((lambda *s: torch.randn(*s, dtype=torch.bfloat16) * 0.1)(D, F)),
            "w_up": _w((lambda *s: torch.randn(*s, dtype=torch.bfloat16) * 0.1)(D, F)),
            "w_down": _w((lambda *s: torch.randn(*s, dtype=torch.bfloat16) * 0.1)(F, D)),
        }
    _B_in = _B_setup()

    return {
        "A_x": _A_in["x"],
        "A_k_cache": _A_in["k_cache"],
        "A_v_cache": _A_in["v_cache"],
        "A_wq": _A_in["wq"],
        "A_wo": _A_in["wo"],
        "B_x": _B_in["x"],
        "B_w_gate": _B_in["w_gate"],
        "B_w_up": _B_in["w_up"],
        "B_w_down": _B_in["w_down"],
    }

def reference(A_x, A_k_cache, A_v_cache, A_wq, A_wo, B_x, B_w_gate, B_w_up, B_w_down):
    def _A_ref(x, k_cache, v_cache, wq, wo):
        B, Sq, D = x.shape
        Hq, Dh = 32, 128
        Hkv = k_cache.shape[1]
        rep = Hq // Hkv
        q = (lambda x, *d: x.permute(*d))((x @ wq).reshape(B, Sq, Hq, Dh), 0, 2, 1, 3)
        k = (lambda x, n, axis: torch.repeat_interleave(x, n, dim=axis))(k_cache, rep, axis=1)
        v = (lambda x, n, axis: torch.repeat_interleave(x, n, dim=axis))(v_cache, rep, axis=1)
        scores = torch.einsum("bhqd,bhkd->bhqk", q, k) * (Dh ** -0.5)
        p = _softmax(scores, axis=-1)
        o = torch.einsum("bhqk,bhkd->bhqd", p, v)
        return (lambda x, *d: x.permute(*d))(o, 0, 2, 1, 3).reshape(B, Sq, Hq * Dh) @ wo

    def _B_ref(x, w_gate, w_up, w_down):
        return (_gelu(x @ w_gate) * (x @ w_up)) @ w_down

    x = A_x
    xn = _layernorm(x, axis=-1)
    s = _A_ref(xn, A_k_cache, A_v_cache, A_wq, A_wo)
    g = _silu(_B_ref(xn, B_w_gate, B_w_up, B_w_down))
    return x + s * g
```

```asm
; @launch grid=(256,1,1) block=(512,1,1) lds=49920
.amdgcn_target "amdgcn-amd-amdhsa--gfx950"
.text
.globl recurrent_scan__gqa_block_cached__geglu_ffn__decode_kernel
.p2align 8
.type recurrent_scan__gqa_block_cached__geglu_ffn__decode_kernel,@function
recurrent_scan__gqa_block_cached__geglu_ffn__decode_kernel:
    s_cmp_ge_u32 s2, 256
    s_cbranch_scc1 L_done
    s_load_dwordx16 s[4:19], s[0:1], 0
    s_load_dwordx8 s[20:27], s[0:1], 64
    v_lshrrev_b32 v1, 6, v0
    v_and_b32 v0, 63, v0
    v_readfirstlane_b32 s3, v1
    s_and_b32 s28, s2, 7
    s_lshr_b32 s29, s2, 3
    s_and_b32 s33, s3, 3
    s_cmp_ge_u32 s3, 4
    s_cbranch_scc0 L_nocpf
    s_cmp_ge_u32 s29, 16
    s_cbranch_scc0 L_nocpf
    s_cmp_ge_u32 s29, 20
    s_cbranch_scc1 L_nocpf
    s_getpc_b64 s[78:79]
L_pc_1:
    s_add_u32 s78, s78, (recurrent_scan__gqa_block_cached__geglu_ffn__decode_kernel - L_pc_1)
    s_addc_u32 s79, s79, (((recurrent_scan__gqa_block_cached__geglu_ffn__decode_kernel - L_pc_1) >> 31) >> 1)
    s_lshl_b32 s35, s33, 10
    v_lshlrev_b32 v10, 4, v0
    v_add_u32 v10, s35, v10
    v_min_u32 v11, (L_done - recurrent_scan__gqa_block_cached__geglu_ffn__decode_kernel - 16), v10
    v_mov_b32 v9, s79
    v_add_co_u32 v8, vcc, s78, v11
    v_addc_co_u32 v9, vcc, 0, v9, vcc
    global_load_dwordx4 a[160:163], v[8:9], off
    v_add_u32 v10, 0x1000, v10
    v_min_u32 v11, (L_done - recurrent_scan__gqa_block_cached__geglu_ffn__decode_kernel - 16), v10
    v_mov_b32 v9, s79
    v_add_co_u32 v8, vcc, s78, v11
    v_addc_co_u32 v9, vcc, 0, v9, vcc
    global_load_dwordx4 a[160:163], v[8:9], off
    v_add_u32 v10, 0x1000, v10
    v_min_u32 v11, (L_done - recurrent_scan__gqa_block_cached__geglu_ffn__decode_kernel - 16), v10
    v_mov_b32 v9, s79
    v_add_co_u32 v8, vcc, s78, v11
    v_addc_co_u32 v9, vcc, 0, v9, vcc
    global_load_dwordx4 a[160:163], v[8:9], off
    v_add_u32 v10, 0x1000, v10
    v_min_u32 v11, (L_done - recurrent_scan__gqa_block_cached__geglu_ffn__decode_kernel - 16), v10
    v_mov_b32 v9, s79
    v_add_co_u32 v8, vcc, s78, v11
    v_addc_co_u32 v9, vcc, 0, v9, vcc
    global_load_dwordx4 a[160:163], v[8:9], off
L_nocpf:
    s_lshr_b32 s35, s29, 3
    s_lshl_b32 s30, s28, 2
    s_add_u32 s35, s35, s30
    s_lshr_b32 s31, s35, 4
    s_and_b32 s30, s35, 15
    s_and_b32 s32, s29, 7
    s_mov_b32 s34, 0x3fb8aa3b
    s_mov_b32 s42, 0
    s_mov_b32 s43, -1
    s_waitcnt lgkmcnt(0)
    s_mov_b32 s60, s26
    s_mov_b32 s61, s27
    s_mov_b32 s62, 1073741824
    s_mov_b32 s63, 0x20000
    s_cmp_ge_u32 s3, 4
    s_cbranch_scc1 L_helper
    s_lshl_b32 s35, s31, 4
    s_add_u32 s35, s35, s30
    s_and_b32 s64, s35, 3
    s_mul_i32 s64, s64, 16
    s_lshr_b32 s36, s35, 2
    s_mul_i32 s36, s36, 7
    s_add_u32 s64, s64, s36
    s_and_b32 s64, s64, 63
    s_lshl_b32 s35, s35, 23
    s_add_u32 s44, s6, s35
    s_addc_u32 s45, s7, 0
    s_mov_b32 s46, 8388608
    s_mov_b32 s47, 0x20000
    s_add_u32 s48, s8, s35
    s_addc_u32 s49, s9, 0
    s_mov_b32 s50, 8388608
    s_mov_b32 s51, 0x20000
    s_lshl_b32 s66, s32, 2
    s_add_u32 s66, s66, s33
    s_lshl_b32 s66, s66, 12
    s_mov_b32 s65, 0
    v_bfe_u32 v1, v0, 2, 2
    v_lshlrev_b32 v1, 8, v1
    v_lshrrev_b32 v2, 4, v0
    v_lshl_add_u32 v1, v2, 6, v1
    v_and_b32 v2, 3, v0
    v_lshl_add_u32 v1, v2, 4, v1
    v_lshlrev_b32 v2, 4, v0
    s_barrier
    s_lshl_b32 s67, s64, 17
    s_add_u32 s67, s67, s66
    s_cmp_ge_u32 s65, 64
    s_cselect_b32 s67, 0x1000000, s67
    s_add_u32 s64, s64, 1
    s_and_b32 s64, s64, 63
    s_add_u32 s65, s65, 1
    buffer_load_dwordx4 a[0:3], v1, s[44:47], s67 offen offset:0 nt
    buffer_load_dwordx4 a[4:7], v1, s[44:47], s67 offen offset:1024 nt
    buffer_load_dwordx4 a[8:11], v1, s[44:47], s67 offen offset:2048 nt
    buffer_load_dwordx4 a[12:15], v1, s[44:47], s67 offen offset:3072 nt
    buffer_load_dwordx4 a[16:19], v2, s[48:51], s67 offen offset:0 nt
    buffer_load_dwordx4 a[20:23], v2, s[48:51], s67 offen offset:1024 nt
    buffer_load_dwordx4 a[24:27], v2, s[48:51], s67 offen offset:2048 nt
    buffer_load_dwordx4 a[28:31], v2, s[48:51], s67 offen offset:3072 nt
    s_lshl_b32 s67, s64, 17
    s_add_u32 s67, s67, s66
    s_cmp_ge_u32 s65, 64
    s_cselect_b32 s67, 0x1000000, s67
    s_add_u32 s64, s64, 1
    s_and_b32 s64, s64, 63
    s_add_u32 s65, s65, 1
    buffer_load_dwordx4 a[32:35], v1, s[44:47], s67 offen offset:0 nt
    buffer_load_dwordx4 a[36:39], v1, s[44:47], s67 offen offset:1024 nt
    buffer_load_dwordx4 a[40:43], v1, s[44:47], s67 offen offset:2048 nt
    buffer_load_dwordx4 a[44:47], v1, s[44:47], s67 offen offset:3072 nt
    buffer_load_dwordx4 a[48:51], v2, s[48:51], s67 offen offset:0 nt
    buffer_load_dwordx4 a[52:55], v2, s[48:51], s67 offen offset:1024 nt
    buffer_load_dwordx4 a[56:59], v2, s[48:51], s67 offen offset:2048 nt
    buffer_load_dwordx4 a[60:63], v2, s[48:51], s67 offen offset:3072 nt
    s_lshl_b32 s67, s64, 17
    s_add_u32 s67, s67, s66
    s_cmp_ge_u32 s65, 64
    s_cselect_b32 s67, 0x1000000, s67
    s_add_u32 s64, s64, 1
    s_and_b32 s64, s64, 63
    s_add_u32 s65, s65, 1
    buffer_load_dwordx4 a[64:67], v1, s[44:47], s67 offen offset:0 nt
    buffer_load_dwordx4 a[68:71], v1, s[44:47], s67 offen offset:1024 nt
    buffer_load_dwordx4 a[72:75], v1, s[44:47], s67 offen offset:2048 nt
    buffer_load_dwordx4 a[76:79], v1, s[44:47], s67 offen offset:3072 nt
    buffer_load_dwordx4 a[80:83], v2, s[48:51], s67 offen offset:0 nt
    buffer_load_dwordx4 a[84:87], v2, s[48:51], s67 offen offset:1024 nt
    buffer_load_dwordx4 a[88:91], v2, s[48:51], s67 offen offset:2048 nt
    buffer_load_dwordx4 a[92:95], v2, s[48:51], s67 offen offset:3072 nt
    v_and_b32 v4, 1, v0
    v_cmp_eq_u32 vcc, 1, v4
    v_mov_b32 v5, 0xffff
    v_mov_b32 v6, 0xffff0000
    v_cndmask_b32 v5, v5, v6, vcc
    v_bfe_u32 v4, v0, 1, 2
    v_cmp_eq_u32 vcc, 0, v4
    s_nop 1
    v_cndmask_b32 v12, 0, v5, vcc
    v_cmp_eq_u32 vcc, 1, v4
    s_nop 1
    v_cndmask_b32 v13, 0, v5, vcc
    v_cmp_eq_u32 vcc, 2, v4
    s_nop 1
    v_cndmask_b32 v14, 0, v5, vcc
    v_cmp_eq_u32 vcc, 3, v4
    s_nop 1
    v_cndmask_b32 v15, 0, v5, vcc
    v_mov_b32 v8, 0
    v_mov_b32 v9, 0
    v_mov_b32 v10, 0
    v_mov_b32 v11, 0
    v_mov_b32 v56, 0xff61b1e6
    v_mov_b32 v57, 0
    v_mov_b32 v58, 0
    v_bfe_u32 v16, v0, 3, 1
    v_lshlrev_b32 v16, 8, v16
    v_lshrrev_b32 v17, 4, v0
    v_lshl_add_u32 v16, v17, 6, v16
    v_and_b32 v17, 3, v0
    v_lshl_add_u32 v16, v17, 4, v16
    v_mov_b32 v18, 0
    s_barrier
    ds_read_b128 v[4:7], v16 offset:8704
    s_waitcnt lgkmcnt(0)
    v_lshrrev_b32 v32, 5, v0
    v_lshlrev_b32 v32, 9, v32
    v_and_b32 v17, 15, v0
    v_lshl_add_u32 v32, v17, 5, v32
    v_bfe_u32 v17, v0, 4, 1
    v_lshl_add_u32 v32, v17, 4, v32
    s_lshl_b32 s35, s33, 10
    v_add_u32 v32, s35, v32
    v_and_b32 v33, 8, v0
    s_lshl_b32 s35, s33, 4
    v_add_u32 v33, s35, v33
    s_lshl_b32 s35, s33, 2
    v_mov_b32 v34, s35
    v_mov_b32 v35, 1
    s_mov_b32 s69, 0
    s_nop 1
L_kv_loop:
    s_waitcnt vmcnt(20)
    v_mfma_f32_16x16x32_bf16 v[16:19], a[0:3], v[4:7], 0
    v_mfma_f32_16x16x32_bf16 v[20:23], a[4:7], v[4:7], 0
    v_mfma_f32_16x16x32_bf16 v[24:27], a[8:11], v[4:7], 0
    v_mfma_f32_16x16x32_bf16 v[28:31], a[12:15], v[4:7], 0
    s_lshl_b32 s67, s64, 17
    s_add_u32 s67, s67, s66
    s_cmp_ge_u32 s65, 64
    s_cselect_b32 s67, 0x1000000, s67
    s_add_u32 s64, s64, 1
    s_and_b32 s64, s64, 63
    s_add_u32 s65, s65, 1
    buffer_load_dwordx4 a[0:3], v1, s[44:47], s67 offen offset:0 nt
    buffer_load_dwordx4 a[4:7], v1, s[44:47], s67 offen offset:1024 nt
    buffer_load_dwordx4 a[8:11], v1, s[44:47], s67 offen offset:2048 nt
    buffer_load_dwordx4 a[12:15], v1, s[44:47], s67 offen offset:3072 nt
    v_mov_b32_dpp v48, v16 quad_perm:[0,0,0,0] row_mask:0xf bank_mask:0xf
    v_mov_b32_dpp v49, v20 quad_perm:[0,0,0,0] row_mask:0xf bank_mask:0xf
    v_mov_b32_dpp v50, v24 quad_perm:[0,0,0,0] row_mask:0xf bank_mask:0xf
    v_mov_b32_dpp v51, v28 quad_perm:[0,0,0,0] row_mask:0xf bank_mask:0xf
    v_add_f32_dpp v48, v17, v48 quad_perm:[1,1,1,1] row_mask:0xf bank_mask:0xf
    v_add_f32_dpp v49, v21, v49 quad_perm:[1,1,1,1] row_mask:0xf bank_mask:0xf
    v_add_f32_dpp v50, v25, v50 quad_perm:[1,1,1,1] row_mask:0xf bank_mask:0xf
    v_add_f32_dpp v51, v29, v51 quad_perm:[1,1,1,1] row_mask:0xf bank_mask:0xf
    v_add_f32_dpp v48, v18, v48 quad_perm:[2,2,2,2] row_mask:0xf bank_mask:0xf
    v_add_f32_dpp v49, v22, v49 quad_perm:[2,2,2,2] row_mask:0xf bank_mask:0xf
    v_add_f32_dpp v50, v26, v50 quad_perm:[2,2,2,2] row_mask:0xf bank_mask:0xf
    v_add_f32_dpp v51, v30, v51 quad_perm:[2,2,2,2] row_mask:0xf bank_mask:0xf
    v_add_f32_dpp v48, v19, v48 quad_perm:[3,3,3,3] row_mask:0xf bank_mask:0xf
    v_add_f32_dpp v49, v23, v49 quad_perm:[3,3,3,3] row_mask:0xf bank_mask:0xf
    v_add_f32_dpp v50, v27, v50 quad_perm:[3,3,3,3] row_mask:0xf bank_mask:0xf
    v_add_f32_dpp v51, v31, v51 quad_perm:[3,3,3,3] row_mask:0xf bank_mask:0xf
    v_cvt_pk_bf16_f32 v16, v48, v49
    v_cvt_pk_bf16_f32 v18, v50, v51
    v_lshlrev_b32 v48, 16, v16
    v_and_b32 v49, 0xffff0000, v16
    v_lshlrev_b32 v50, 16, v18
    v_and_b32 v51, 0xffff0000, v18
    v_mul_f32 v48, 0x3db504f3, v48
    v_mul_f32 v49, 0x3db504f3, v49
    v_mul_f32 v50, 0x3db504f3, v50
    v_mul_f32 v51, 0x3db504f3, v51
    v_cvt_pk_bf16_f32 v16, v48, v49
    v_cvt_pk_bf16_f32 v18, v50, v51
    v_lshlrev_b32 v48, 16, v16
    v_and_b32 v49, 0xffff0000, v16
    v_lshlrev_b32 v50, 16, v18
    v_and_b32 v51, 0xffff0000, v18
    v_max3_f32 v59, v48, v49, v50
    v_max_f32 v59, v59, v51
    v_cmp_gt_f32 vcc, v59, v56
    s_cbranch_vccnz L_rare0
L_back0:
    v_fma_f32 v48, v48, s34, v57
    v_fma_f32 v49, v49, s34, v57
    v_fma_f32 v50, v50, s34, v57
    v_fma_f32 v51, v51, s34, v57
    v_exp_f32 v48, v48
    v_exp_f32 v49, v49
    v_exp_f32 v50, v50
    v_exp_f32 v51, v51
    s_waitcnt vmcnt(20)
    v_add_f32 v60, v48, v49
    v_add_f32 v61, v50, v51
    v_add_f32 v60, v60, v61
    v_add_f32 v58, v58, v60
    v_cvt_pk_bf16_f32 v24, v48, v48
    v_and_b32 v16, v12, v24
    v_and_b32 v17, v13, v24
    v_and_b32 v18, v14, v24
    v_and_b32 v19, v15, v24
    v_cvt_pk_bf16_f32 v24, v49, v49
    v_and_b32 v20, v12, v24
    v_and_b32 v21, v13, v24
    v_and_b32 v22, v14, v24
    v_and_b32 v23, v15, v24
    v_mfma_f32_16x16x32_bf16 v[8:11], v[16:19], a[16:19], v[8:11]
    v_cvt_pk_bf16_f32 v24, v50, v50
    v_and_b32 v16, v12, v24
    v_and_b32 v17, v13, v24
    v_and_b32 v18, v14, v24
    v_and_b32 v19, v15, v24
    v_mfma_f32_16x16x32_bf16 v[8:11], v[20:23], a[20:23], v[8:11]
    v_cvt_pk_bf16_f32 v24, v51, v51
    v_and_b32 v20, v12, v24
    v_and_b32 v21, v13, v24
    v_and_b32 v22, v14, v24
    v_and_b32 v23, v15, v24
    v_mfma_f32_16x16x32_bf16 v[8:11], v[16:19], a[24:27], v[8:11]
    s_nop 1
    v_mfma_f32_16x16x32_bf16 v[8:11], v[20:23], a[28:31], v[8:11]
    buffer_load_dwordx4 a[16:19], v2, s[48:51], s67 offen offset:0 nt
    buffer_load_dwordx4 a[20:23], v2, s[48:51], s67 offen offset:1024 nt
    buffer_load_dwordx4 a[24:27], v2, s[48:51], s67 offen offset:2048 nt
    buffer_load_dwordx4 a[28:31], v2, s[48:51], s67 offen offset:3072 nt
    s_add_u32 s69, s69, 1
    s_cmp_eq_u32 s69, 62
    s_cbranch_scc0 L_nox_2
    v_mov_b32 v60, 0
    v_mov_b32 v61, 1
    ds_write_b32 v60, v61 offset:9248
L_nox_2:
    s_cmp_eq_u32 s69, 64
    s_cbranch_scc1 L_kv_end
    s_waitcnt vmcnt(20)
    v_mfma_f32_16x16x32_bf16 v[16:19], a[32:35], v[4:7], 0
    v_mfma_f32_16x16x32_bf16 v[20:23], a[36:39], v[4:7], 0
    v_mfma_f32_16x16x32_bf16 v[24:27], a[40:43], v[4:7], 0
    v_mfma_f32_16x16x32_bf16 v[28:31], a[44:47], v[4:7], 0
    s_lshl_b32 s67, s64, 17
    s_add_u32 s67, s67, s66
    s_cmp_ge_u32 s65, 64
    s_cselect_b32 s67, 0x1000000, s67
    s_add_u32 s64, s64, 1
    s_and_b32 s64, s64, 63
    s_add_u32 s65, s65, 1
    buffer_load_dwordx4 a[32:35], v1, s[44:47], s67 offen offset:0 nt
    buffer_load_dwordx4 a[36:39], v1, s[44:47], s67 offen offset:1024 nt
    buffer_load_dwordx4 a[40:43], v1, s[44:47], s67 offen offset:2048 nt
    buffer_load_dwordx4 a[44:47], v1, s[44:47], s67 offen offset:3072 nt
    v_mov_b32_dpp v48, v16 quad_perm:[0,0,0,0] row_mask:0xf bank_mask:0xf
    v_mov_b32_dpp v49, v20 quad_perm:[0,0,0,0] row_mask:0xf bank_mask:0xf
    v_mov_b32_dpp v50, v24 quad_perm:[0,0,0,0] row_mask:0xf bank_mask:0xf
    v_mov_b32_dpp v51, v28 quad_perm:[0,0,0,0] row_mask:0xf bank_mask:0xf
    v_add_f32_dpp v48, v17, v48 quad_perm:[1,1,1,1] row_mask:0xf bank_mask:0xf
    v_add_f32_dpp v49, v21, v49 quad_perm:[1,1,1,1] row_mask:0xf bank_mask:0xf
    v_add_f32_dpp v50, v25, v50 quad_perm:[1,1,1,1] row_mask:0xf bank_mask:0xf
    v_add_f32_dpp v51, v29, v51 quad_perm:[1,1,1,1] row_mask:0xf bank_mask:0xf
    v_add_f32_dpp v48, v18, v48 quad_perm:[2,2,2,2] row_mask:0xf bank_mask:0xf
    v_add_f32_dpp v49, v22, v49 quad_perm:[2,2,2,2] row_mask:0xf bank_mask:0xf
    v_add_f32_dpp v50, v26, v50 quad_perm:[2,2,2,2] row_mask:0xf bank_mask:0xf
    v_add_f32_dpp v51, v30, v51 quad_perm:[2,2,2,2] row_mask:0xf bank_mask:0xf
    v_add_f32_dpp v48, v19, v48 quad_perm:[3,3,3,3] row_mask:0xf bank_mask:0xf
    v_add_f32_dpp v49, v23, v49 quad_perm:[3,3,3,3] row_mask:0xf bank_mask:0xf
    v_add_f32_dpp v50, v27, v50 quad_perm:[3,3,3,3] row_mask:0xf bank_mask:0xf
    v_add_f32_dpp v51, v31, v51 quad_perm:[3,3,3,3] row_mask:0xf bank_mask:0xf
    v_cvt_pk_bf16_f32 v16, v48, v49
    v_cvt_pk_bf16_f32 v18, v50, v51
    v_lshlrev_b32 v48, 16, v16
    v_and_b32 v49, 0xffff0000, v16
    v_lshlrev_b32 v50, 16, v18
    v_and_b32 v51, 0xffff0000, v18
    v_mul_f32 v48, 0x3db504f3, v48
    v_mul_f32 v49, 0x3db504f3, v49
    v_mul_f32 v50, 0x3db504f3, v50
    v_mul_f32 v51, 0x3db504f3, v51
    v_cvt_pk_bf16_f32 v16, v48, v49
    v_cvt_pk_bf16_f32 v18, v50, v51
    v_lshlrev_b32 v48, 16, v16
    v_and_b32 v49, 0xffff0000, v16
    v_lshlrev_b32 v50, 16, v18
    v_and_b32 v51, 0xffff0000, v18
    v_max3_f32 v59, v48, v49, v50
    v_max_f32 v59, v59, v51
    v_cmp_gt_f32 vcc, v59, v56
    s_cbranch_vccnz L_rare1
L_back1:
    v_fma_f32 v48, v48, s34, v57
    v_fma_f32 v49, v49, s34, v57
    v_fma_f32 v50, v50, s34, v57
    v_fma_f32 v51, v51, s34, v57
    v_exp_f32 v48, v48
    v_exp_f32 v49, v49
    v_exp_f32 v50, v50
    v_exp_f32 v51, v51
    s_waitcnt vmcnt(20)
    v_add_f32 v60, v48, v49
    v_add_f32 v61, v50, v51
    v_add_f32 v60, v60, v61
    v_add_f32 v58, v58, v60
    v_cvt_pk_bf16_f32 v24, v48, v48
    v_and_b32 v16, v12, v24
    v_and_b32 v17, v13, v24
    v_and_b32 v18, v14, v24
    v_and_b32 v19, v15, v24
    v_cvt_pk_bf16_f32 v24, v49, v49
    v_and_b32 v20, v12, v24
    v_and_b32 v21, v13, v24
    v_and_b32 v22, v14, v24
    v_and_b32 v23, v15, v24
    v_mfma_f32_16x16x32_bf16 v[8:11], v[16:19], a[48:51], v[8:11]
    v_cvt_pk_bf16_f32 v24, v50, v50
    v_and_b32 v16, v12, v24
    v_and_b32 v17, v13, v24
    v_and_b32 v18, v14, v24
    v_and_b32 v19, v15, v24
    v_mfma_f32_16x16x32_bf16 v[8:11], v[20:23], a[52:55], v[8:11]
    v_cvt_pk_bf16_f32 v24, v51, v51
    v_and_b32 v20, v12, v24
    v_and_b32 v21, v13, v24
    v_and_b32 v22, v14, v24
    v_and_b32 v23, v15, v24
    v_mfma_f32_16x16x32_bf16 v[8:11], v[16:19], a[56:59], v[8:11]
    s_nop 1
    v_mfma_f32_16x16x32_bf16 v[8:11], v[20:23], a[60:63], v[8:11]
    buffer_load_dwordx4 a[48:51], v2, s[48:51], s67 offen offset:0 nt
    buffer_load_dwordx4 a[52:55], v2, s[48:51], s67 offen offset:1024 nt
    buffer_load_dwordx4 a[56:59], v2, s[48:51], s67 offen offset:2048 nt
    buffer_load_dwordx4 a[60:63], v2, s[48:51], s67 offen offset:3072 nt
    s_add_u32 s69, s69, 1
    s_cmp_eq_u32 s69, 62
    s_cbranch_scc0 L_nox_3
    v_mov_b32 v60, 0
    v_mov_b32 v61, 1
    ds_write_b32 v60, v61 offset:9248
L_nox_3:
    s_cmp_eq_u32 s69, 64
    s_cbranch_scc1 L_kv_end
    s_waitcnt vmcnt(20)
    v_mfma_f32_16x16x32_bf16 v[16:19], a[64:67], v[4:7], 0
    v_mfma_f32_16x16x32_bf16 v[20:23], a[68:71], v[4:7], 0
    v_mfma_f32_16x16x32_bf16 v[24:27], a[72:75], v[4:7], 0
    v_mfma_f32_16x16x32_bf16 v[28:31], a[76:79], v[4:7], 0
    s_lshl_b32 s67, s64, 17
    s_add_u32 s67, s67, s66
    s_cmp_ge_u32 s65, 64
    s_cselect_b32 s67, 0x1000000, s67
    s_add_u32 s64, s64, 1
    s_and_b32 s64, s64, 63
    s_add_u32 s65, s65, 1
    buffer_load_dwordx4 a[64:67], v1, s[44:47], s67 offen offset:0 nt
    buffer_load_dwordx4 a[68:71], v1, s[44:47], s67 offen offset:1024 nt
    buffer_load_dwordx4 a[72:75], v1, s[44:47], s67 offen offset:2048 nt
    buffer_load_dwordx4 a[76:79], v1, s[44:47], s67 offen offset:3072 nt
    v_mov_b32_dpp v48, v16 quad_perm:[0,0,0,0] row_mask:0xf bank_mask:0xf
    v_mov_b32_dpp v49, v20 quad_perm:[0,0,0,0] row_mask:0xf bank_mask:0xf
    v_mov_b32_dpp v50, v24 quad_perm:[0,0,0,0] row_mask:0xf bank_mask:0xf
    v_mov_b32_dpp v51, v28 quad_perm:[0,0,0,0] row_mask:0xf bank_mask:0xf
    v_add_f32_dpp v48, v17, v48 quad_perm:[1,1,1,1] row_mask:0xf bank_mask:0xf
    v_add_f32_dpp v49, v21, v49 quad_perm:[1,1,1,1] row_mask:0xf bank_mask:0xf
    v_add_f32_dpp v50, v25, v50 quad_perm:[1,1,1,1] row_mask:0xf bank_mask:0xf
    v_add_f32_dpp v51, v29, v51 quad_perm:[1,1,1,1] row_mask:0xf bank_mask:0xf
    v_add_f32_dpp v48, v18, v48 quad_perm:[2,2,2,2] row_mask:0xf bank_mask:0xf
    v_add_f32_dpp v49, v22, v49 quad_perm:[2,2,2,2] row_mask:0xf bank_mask:0xf
    v_add_f32_dpp v50, v26, v50 quad_perm:[2,2,2,2] row_mask:0xf bank_mask:0xf
    v_add_f32_dpp v51, v30, v51 quad_perm:[2,2,2,2] row_mask:0xf bank_mask:0xf
    v_add_f32_dpp v48, v19, v48 quad_perm:[3,3,3,3] row_mask:0xf bank_mask:0xf
    v_add_f32_dpp v49, v23, v49 quad_perm:[3,3,3,3] row_mask:0xf bank_mask:0xf
    v_add_f32_dpp v50, v27, v50 quad_perm:[3,3,3,3] row_mask:0xf bank_mask:0xf
    v_add_f32_dpp v51, v31, v51 quad_perm:[3,3,3,3] row_mask:0xf bank_mask:0xf
    v_cvt_pk_bf16_f32 v16, v48, v49
    v_cvt_pk_bf16_f32 v18, v50, v51
    v_lshlrev_b32 v48, 16, v16
    v_and_b32 v49, 0xffff0000, v16
    v_lshlrev_b32 v50, 16, v18
    v_and_b32 v51, 0xffff0000, v18
    v_mul_f32 v48, 0x3db504f3, v48
    v_mul_f32 v49, 0x3db504f3, v49
    v_mul_f32 v50, 0x3db504f3, v50
    v_mul_f32 v51, 0x3db504f3, v51
    v_cvt_pk_bf16_f32 v16, v48, v49
    v_cvt_pk_bf16_f32 v18, v50, v51
    v_lshlrev_b32 v48, 16, v16
    v_and_b32 v49, 0xffff0000, v16
    v_lshlrev_b32 v50, 16, v18
    v_and_b32 v51, 0xffff0000, v18
    v_max3_f32 v59, v48, v49, v50
    v_max_f32 v59, v59, v51
    v_cmp_gt_f32 vcc, v59, v56
    s_cbranch_vccnz L_rare2
L_back2:
    v_fma_f32 v48, v48, s34, v57
    v_fma_f32 v49, v49, s34, v57
    v_fma_f32 v50, v50, s34, v57
    v_fma_f32 v51, v51, s34, v57
    v_exp_f32 v48, v48
    v_exp_f32 v49, v49
    v_exp_f32 v50, v50
    v_exp_f32 v51, v51
    s_waitcnt vmcnt(20)
    v_add_f32 v60, v48, v49
    v_add_f32 v61, v50, v51
    v_add_f32 v60, v60, v61
    v_add_f32 v58, v58, v60
    v_cvt_pk_bf16_f32 v24, v48, v48
    v_and_b32 v16, v12, v24
    v_and_b32 v17, v13, v24
    v_and_b32 v18, v14, v24
    v_and_b32 v19, v15, v24
    v_cvt_pk_bf16_f32 v24, v49, v49
    v_and_b32 v20, v12, v24
    v_and_b32 v21, v13, v24
    v_and_b32 v22, v14, v24
    v_and_b32 v23, v15, v24
    v_mfma_f32_16x16x32_bf16 v[8:11], v[16:19], a[80:83], v[8:11]
    v_cvt_pk_bf16_f32 v24, v50, v50
    v_and_b32 v16, v12, v24
    v_and_b32 v17, v13, v24
    v_and_b32 v18, v14, v24
    v_and_b32 v19, v15, v24
    v_mfma_f32_16x16x32_bf16 v[8:11], v[20:23], a[84:87], v[8:11]
    v_cvt_pk_bf16_f32 v24, v51, v51
    v_and_b32 v20, v12, v24
    v_and_b32 v21, v13, v24
    v_and_b32 v22, v14, v24
    v_and_b32 v23, v15, v24
    v_mfma_f32_16x16x32_bf16 v[8:11], v[16:19], a[88:91], v[8:11]
    s_nop 1
    v_mfma_f32_16x16x32_bf16 v[8:11], v[20:23], a[92:95], v[8:11]
    buffer_load_dwordx4 a[80:83], v2, s[48:51], s67 offen offset:0 nt
    buffer_load_dwordx4 a[84:87], v2, s[48:51], s67 offen offset:1024 nt
    buffer_load_dwordx4 a[88:91], v2, s[48:51], s67 offen offset:2048 nt
    buffer_load_dwordx4 a[92:95], v2, s[48:51], s67 offen offset:3072 nt
    s_add_u32 s69, s69, 1
    s_cmp_eq_u32 s69, 62
    s_cbranch_scc0 L_nox_4
    v_mov_b32 v60, 0
    v_mov_b32 v61, 1
    ds_write_b32 v60, v61 offset:9248
L_nox_4:
    s_cmp_eq_u32 s69, 64
    s_cbranch_scc1 L_kv_end
    s_branch L_kv_loop
L_rare0:
    v_mov_b32 v60, v59
    s_nop 1
    v_permlane16_swap_b32 v59, v60
    s_nop 1
    v_max_f32 v59, v59, v60
    v_mov_b32 v60, v59
    s_nop 1
    v_permlane32_swap_b32 v59, v60
    s_nop 1
    v_max_f32 v59, v59, v60
    v_max_f32 v59, v59, v56
    v_sub_f32 v60, v56, v59
    v_mul_f32 v60, s34, v60
    v_exp_f32 v60, v60
    v_mov_b32 v56, v59
    v_mul_f32 v57, s34, v59
    v_mul_f32 v58, v58, v60
    v_sub_f32 v57, 0, v57
    v_readlane_b32 s70, v60, 0
    v_readlane_b32 s71, v60, 8
    s_nop 1
    v_mov_b32 v61, s70
    v_mov_b32 v62, s71
    v_cndmask_b32 v61, v61, v62, s[42:43]
    v_mul_f32 v8, v8, v61
    v_mul_f32 v9, v9, v61
    v_mul_f32 v10, v10, v61
    v_mul_f32 v11, v11, v61
    s_branch L_back0
L_rare1:
    v_mov_b32 v60, v59
    s_nop 1
    v_permlane16_swap_b32 v59, v60
    s_nop 1
    v_max_f32 v59, v59, v60
    v_mov_b32 v60, v59
    s_nop 1
    v_permlane32_swap_b32 v59, v60
    s_nop 1
    v_max_f32 v59, v59, v60
    v_max_f32 v59, v59, v56
    v_sub_f32 v60, v56, v59
    v_mul_f32 v60, s34, v60
    v_exp_f32 v60, v60
    v_mov_b32 v56, v59
    v_mul_f32 v57, s34, v59
    v_mul_f32 v58, v58, v60
    v_sub_f32 v57, 0, v57
    v_readlane_b32 s70, v60, 0
    v_readlane_b32 s71, v60, 8
    s_nop 1
    v_mov_b32 v61, s70
    v_mov_b32 v62, s71
    v_cndmask_b32 v61, v61, v62, s[42:43]
    v_mul_f32 v8, v8, v61
    v_mul_f32 v9, v9, v61
    v_mul_f32 v10, v10, v61
    v_mul_f32 v11, v11, v61
    s_branch L_back1
L_rare2:
    v_mov_b32 v60, v59
    s_nop 1
    v_permlane16_swap_b32 v59, v60
    s_nop 1
    v_max_f32 v59, v59, v60
    v_mov_b32 v60, v59
    s_nop 1
    v_permlane32_swap_b32 v59, v60
    s_nop 1
    v_max_f32 v59, v59, v60
    v_max_f32 v59, v59, v56
    v_sub_f32 v60, v56, v59
    v_mul_f32 v60, s34, v60
    v_exp_f32 v60, v60
    v_mov_b32 v56, v59
    v_mul_f32 v57, s34, v59
    v_mul_f32 v58, v58, v60
    v_sub_f32 v57, 0, v57
    v_readlane_b32 s70, v60, 0
    v_readlane_b32 s71, v60, 8
    s_nop 1
    v_mov_b32 v61, s70
    v_mov_b32 v62, s71
    v_cndmask_b32 v61, v61, v62, s[42:43]
    v_mul_f32 v8, v8, v61
    v_mul_f32 v9, v9, v61
    v_mul_f32 v10, v10, v61
    v_mul_f32 v11, v11, v61
    s_branch L_back2
L_kv_end:
    v_mov_b32 v60, v58
    s_nop 1
    v_permlane16_swap_b32 v58, v60
    s_nop 1
    v_add_f32 v58, v58, v60
    v_mov_b32 v60, v58
    s_nop 1
    v_permlane32_swap_b32 v58, v60
    s_nop 1
    v_add_f32 v58, v58, v60
    ds_write_b128 v32, v[8:11] offset:9280
    v_mov_b32 v18, v56
    v_mov_b32 v19, v58
    s_mov_b64 exec, 0x101
    ds_write_b64 v33, v[18:19] offset:13376
    s_mov_b64 exec, -1
    s_waitcnt lgkmcnt(0)
    ds_write_b32 v34, v35 offset:9232
    v_mov_b32 v19, 1
    v_mov_b32 v20, 0
    ds_read_b32 v20, v20 offset:9252
    v_mov_b32 v10, 0
L_wflag_5:
    ds_read_b128 v[4:7], v10 offset:9232
    s_waitcnt lgkmcnt(0)
    v_min3_u32 v4, v4, v5, v6
    v_min_u32 v4, v4, v7
    v_cmp_eq_u32 vcc, 0, v4
    s_cbranch_vccnz L_wflag_5
    v_readfirstlane_b32 s82, v20
    s_lshr_b32 s35, s33, 1
    s_lshl_b32 s36, s35, 3
    v_mov_b32 v16, s36
    ds_read_b64 v[20:21], v16 offset:13376
    ds_read_b64 v[22:23], v16 offset:13392
    ds_read_b64 v[24:25], v16 offset:13408
    ds_read_b64 v[26:27], v16 offset:13424
    s_lshl_b32 s36, s33, 8
    v_lshlrev_b32 v17, 2, v0
    v_add_u32 v17, s36, v17
    ds_read_b32 v28, v17 offset:9280
    ds_read_b32 v29, v17 offset:10304
    ds_read_b32 v30, v17 offset:11328
    ds_read_b32 v31, v17 offset:12352
    s_lshl_b32 s36, s30, 1
    s_add_u32 s36, s36, s31
    s_lshl_b32 s36, s36, 3
    s_add_u32 s36, s36, s32
    s_lshl_b32 s36, s36, 12
    s_add_u32 s36, s36, 1048576
    v_lshlrev_b32 v18, 1, v17
    v_lshlrev_b32 v16, 1, v16
    s_waitcnt lgkmcnt(0)
    v_max3_f32 v32, v20, v22, v24
    v_max_f32 v32, v32, v26
    v_sub_f32 v33, v20, v32
    v_sub_f32 v34, v22, v32
    v_sub_f32 v35, v24, v32
    v_sub_f32 v36, v26, v32
    v_mul_f32 v33, s34, v33
    v_mul_f32 v34, s34, v34
    v_mul_f32 v35, s34, v35
    v_mul_f32 v36, s34, v36
    v_exp_f32 v33, v33
    v_exp_f32 v34, v34
    v_exp_f32 v35, v35
    v_exp_f32 v36, v36
    v_mov_b32 v41, s82
    v_mul_f32 v40, v28, v33
    v_mul_f32 v46, v21, v33
    v_fmac_f32 v40, v29, v34
    v_fmac_f32 v46, v23, v34
    v_fmac_f32 v40, v30, v35
    v_fmac_f32 v46, v25, v35
    v_fmac_f32 v40, v31, v36
    v_fmac_f32 v46, v27, v36
    buffer_store_dwordx2 v[40:41], v18, s[60:63], s36 offen sc1
    s_and_b32 s37, s33, 1
    s_cmp_eq_u32 s37, 0
    s_cbranch_scc0 L_noml
    v_mov_b32 v44, v32
    v_mov_b32 v45, v41
    v_mov_b32 v47, v41
    s_mov_b64 exec, 1
    buffer_store_dwordx4 v[44:47], v16, s[60:63], s36 offen offset:2048 sc1
    s_mov_b64 exec, -1
L_noml:
    s_endpgm
L_claim_next:
    s_mov_b32 s56, s24
    s_mov_b32 s57, s25
    s_mov_b32 s58, 256
    s_mov_b32 s59, 0x20000
    s_cmp_eq_u32 s33, 0
    s_cbranch_scc0 L_claim_wait
    v_mov_b32 v20, 1
    v_mov_b32 v21, 0
    s_mov_b64 exec, 1
    buffer_atomic_add v20, v21, s[56:59], 0 offen sc0
    s_waitcnt vmcnt(0)
    ds_write_b32 v21, v20 offset:9256
    s_waitcnt lgkmcnt(0)
    s_mov_b64 exec, -1
L_claim_wait:
    s_add_u32 s85, s85, 1
    s_lshl_b32 s35, s33, 2
    v_mov_b32 v8, s35
    v_mov_b32 v9, s85
    v_mov_b32 v10, 0
    s_waitcnt lgkmcnt(0)
    ds_write_b32 v8, v9 offset:9216
L_hsync_6:
    ds_read_b128 v[4:7], v10 offset:9216
    s_waitcnt lgkmcnt(0)
    v_min3_u32 v4, v4, v5, v6
    v_min_u32 v4, v4, v7
    v_cmp_gt_u32 vcc, s85, v4
    s_cbranch_vccnz L_hsync_6
    v_mov_b32 v21, 0
    ds_read_b32 v20, v21 offset:9256
    s_waitcnt lgkmcnt(0)
    v_readfirstlane_b32 s84, v20
    s_cmp_ge_u32 s84, 72
    s_cbranch_scc1 L_notffn
    s_mov_b32 s44, s16
    s_mov_b32 s45, s17
    s_mov_b32 s46, 5308416
    s_mov_b32 s47, 0x20000
    s_mov_b32 s48, s18
    s_mov_b32 s49, s19
    s_mov_b32 s50, 5308416
    s_mov_b32 s51, 0x20000
    s_mov_b32 s52, s20
    s_mov_b32 s53, s21
    s_mov_b32 s54, 5308416
    s_mov_b32 s55, 0x20000
    v_lshrrev_b32 v2, 3, v0
    v_mul_u32_u24 v2, 18432, v2
    v_and_b32 v60, 7, v0
    v_lshl_add_u32 v2, v60, 4, v2
    s_mul_i32 s67, s33, 1327104
    s_lshl_b32 s35, s84, 7
    s_add_u32 s67, s67, s35
    s_add_u32 s68, s67, 0
    buffer_load_dwordx4 a[0:3], v2, s[44:47], s68 offen nt
    buffer_load_dwordx4 a[4:7], v2, s[48:51], s68 offen nt
    s_add_u32 s68, s67, 9216
    buffer_load_dwordx4 a[8:11], v2, s[44:47], s68 offen nt
    buffer_load_dwordx4 a[12:15], v2, s[48:51], s68 offen nt
    s_add_u32 s68, s67, 147456
    buffer_load_dwordx4 a[16:19], v2, s[44:47], s68 offen nt
    buffer_load_dwordx4 a[20:23], v2, s[48:51], s68 offen nt
    s_add_u32 s68, s67, 156672
    buffer_load_dwordx4 a[24:27], v2, s[44:47], s68 offen nt
    buffer_load_dwordx4 a[28:31], v2, s[48:51], s68 offen nt
    s_add_u32 s68, s67, 294912
    buffer_load_dwordx4 a[32:35], v2, s[44:47], s68 offen nt
    buffer_load_dwordx4 a[36:39], v2, s[48:51], s68 offen nt
    s_add_u32 s68, s67, 304128
    buffer_load_dwordx4 a[40:43], v2, s[44:47], s68 offen nt
    buffer_load_dwordx4 a[44:47], v2, s[48:51], s68 offen nt
    s_add_u32 s68, s67, 442368
    buffer_load_dwordx4 a[48:51], v2, s[44:47], s68 offen nt
    buffer_load_dwordx4 a[52:55], v2, s[48:51], s68 offen nt
    s_add_u32 s68, s67, 451584
    buffer_load_dwordx4 a[56:59], v2, s[44:47], s68 offen nt
    buffer_load_dwordx4 a[60:63], v2, s[48:51], s68 offen nt
    s_add_u32 s68, s67, 589824
    buffer_load_dwordx4 a[64:67], v2, s[44:47], s68 offen nt
    buffer_load_dwordx4 a[68:71], v2, s[48:51], s68 offen nt
    s_add_u32 s68, s67, 599040
    buffer_load_dwordx4 a[72:75], v2, s[44:47], s68 offen nt
    buffer_load_dwordx4 a[76:79], v2, s[48:51], s68 offen nt
    s_add_u32 s68, s67, 737280
    buffer_load_dwordx4 a[80:83], v2, s[44:47], s68 offen nt
    buffer_load_dwordx4 a[84:87], v2, s[48:51], s68 offen nt
    s_add_u32 s68, s67, 746496
    buffer_load_dwordx4 a[88:91], v2, s[44:47], s68 offen nt
    buffer_load_dwordx4 a[92:95], v2, s[48:51], s68 offen nt
    s_add_u32 s68, s67, 884736
    buffer_load_dwordx4 a[96:99], v2, s[44:47], s68 offen nt
    buffer_load_dwordx4 a[100:103], v2, s[48:51], s68 offen nt
    s_add_u32 s68, s67, 893952
    buffer_load_dwordx4 a[104:107], v2, s[44:47], s68 offen nt
    buffer_load_dwordx4 a[108:111], v2, s[48:51], s68 offen nt
    s_add_u32 s68, s67, 1032192
    buffer_load_dwordx4 a[112:115], v2, s[44:47], s68 offen nt
    buffer_load_dwordx4 a[116:119], v2, s[48:51], s68 offen nt
    s_add_u32 s68, s67, 1041408
    buffer_load_dwordx4 a[120:123], v2, s[44:47], s68 offen nt
    buffer_load_dwordx4 a[124:127], v2, s[48:51], s68 offen nt
    s_add_u32 s68, s67, 1179648
    buffer_load_dwordx4 a[128:131], v2, s[44:47], s68 offen nt
    buffer_load_dwordx4 a[132:135], v2, s[48:51], s68 offen nt
    s_add_u32 s68, s67, 1188864
    buffer_load_dwordx4 a[136:139], v2, s[44:47], s68 offen nt
    buffer_load_dwordx4 a[140:143], v2, s[48:51], s68 offen nt
    v_lshrrev_b32 v63, 4, v0
    v_mul_u32_u24 v63, 4608, v63
    v_and_b32 v60, 15, v0
    v_lshl_add_u32 v63, v60, 4, v63
    s_lshl_b32 s35, s84, 6
    s_lshl_b32 s36, s33, 4
    s_add_u32 s35, s35, s36
    s_mul_i32 s38, s35, 1152
    s_add_u32 s68, s38, 0
    buffer_load_dwordx4 a[144:147], v63, s[52:55], s68 offen offset:0 nt
    buffer_load_dwordx4 a[148:151], v63, s[52:55], s68 offen offset:256 nt
    buffer_load_dwordx4 a[152:155], v63, s[52:55], s68 offen offset:512 nt
    buffer_load_dwordx4 a[156:159], v63, s[52:55], s68 offen offset:768 nt
    buffer_load_dwordx4 a[160:163], v63, s[52:55], s68 offen offset:1024 nt
    s_add_u32 s68, s38, 1152
    buffer_load_dwordx4 a[164:167], v63, s[52:55], s68 offen offset:0 nt
    buffer_load_dwordx4 a[168:171], v63, s[52:55], s68 offen offset:256 nt
    buffer_load_dwordx4 a[172:175], v63, s[52:55], s68 offen offset:512 nt
    buffer_load_dwordx4 a[176:179], v63, s[52:55], s68 offen offset:768 nt
    buffer_load_dwordx4 a[180:183], v63, s[52:55], s68 offen offset:1024 nt
    s_add_u32 s68, s38, 2304
    buffer_load_dwordx4 a[184:187], v63, s[52:55], s68 offen offset:0 nt
    buffer_load_dwordx4 a[188:191], v63, s[52:55], s68 offen offset:256 nt
    v_lshrrev_b32 v61, 3, v0
    v_lshlrev_b32 v61, 3, v61
    s_mul_i32 s35, s33, 576
    v_add_u32 v61, s35, v61
    ds_read_b64 v[16:17], v61 offset:0
    ds_read_b64 v[18:19], v61 offset:2304
    s_waitcnt lgkmcnt(0)
    v_and_b32 v24, v12, v16
    v_and_b32 v25, v13, v16
    v_and_b32 v26, v14, v16
    v_and_b32 v27, v15, v16
    v_and_b32 v28, v12, v18
    v_and_b32 v29, v13, v18
    v_and_b32 v30, v14, v18
    v_and_b32 v31, v15, v18
    s_waitcnt vmcnt(46)
    s_nop 0
    v_mfma_f32_16x16x32_bf16 v[32:35], v[24:27], a[0:3], 0
    v_mfma_f32_16x16x32_bf16 v[36:39], v[28:31], a[0:3], 0
    v_mfma_f32_16x16x32_bf16 v[40:43], v[24:27], a[4:7], 0
    v_mfma_f32_16x16x32_bf16 v[44:47], v[28:31], a[4:7], 0
    v_and_b32 v24, v12, v17
    v_and_b32 v25, v13, v17
    v_and_b32 v26, v14, v17
    v_and_b32 v27, v15, v17
    v_and_b32 v28, v12, v19
    v_and_b32 v29, v13, v19
    v_and_b32 v30, v14, v19
    v_and_b32 v31, v15, v19
    s_waitcnt vmcnt(44)
    s_nop 0
    v_mfma_f32_16x16x32_bf16 v[32:35], v[24:27], a[8:11], v[32:35]
    v_mfma_f32_16x16x32_bf16 v[36:39], v[28:31], a[8:11], v[36:39]
    v_mfma_f32_16x16x32_bf16 v[40:43], v[24:27], a[12:15], v[40:43]
    v_mfma_f32_16x16x32_bf16 v[44:47], v[28:31], a[12:15], v[44:47]
    ds_read_b64 v[16:17], v61 offset:64
    ds_read_b64 v[18:19], v61 offset:2368
    s_waitcnt lgkmcnt(0)
    v_and_b32 v24, v12, v16
    v_and_b32 v25, v13, v16
    v_and_b32 v26, v14, v16
    v_and_b32 v27, v15, v16
    v_and_b32 v28, v12, v18
    v_and_b32 v29, v13, v18
    v_and_b32 v30, v14, v18
    v_and_b32 v31, v15, v18
    s_waitcnt vmcnt(42)
    s_nop 0
    v_mfma_f32_16x16x32_bf16 v[32:35], v[24:27], a[16:19], v[32:35]
    v_mfma_f32_16x16x32_bf16 v[36:39], v[28:31], a[16:19], v[36:39]
    v_mfma_f32_16x16x32_bf16 v[40:43], v[24:27], a[20:23], v[40:43]
    v_mfma_f32_16x16x32_bf16 v[44:47], v[28:31], a[20:23], v[44:47]
    v_and_b32 v24, v12, v17
    v_and_b32 v25, v13, v17
    v_and_b32 v26, v14, v17
    v_and_b32 v27, v15, v17
    v_and_b32 v28, v12, v19
    v_and_b32 v29, v13, v19
    v_and_b32 v30, v14, v19
    v_and_b32 v31, v15, v19
    s_waitcnt vmcnt(40)
    s_nop 0
    v_mfma_f32_16x16x32_bf16 v[32:35], v[24:27], a[24:27], v[32:35]
    v_mfma_f32_16x16x32_bf16 v[36:39], v[28:31], a[24:27], v[36:39]
    v_mfma_f32_16x16x32_bf16 v[40:43], v[24:27], a[28:31], v[40:43]
    v_mfma_f32_16x16x32_bf16 v[44:47], v[28:31], a[28:31], v[44:47]
    s_add_u32 s68, s38, 2304
    buffer_load_dwordx4 a[0:3], v63, s[52:55], s68 offen offset:512 nt
    buffer_load_dwordx4 a[4:7], v63, s[52:55], s68 offen offset:768 nt
    buffer_load_dwordx4 a[8:11], v63, s[52:55], s68 offen offset:1024 nt
    s_add_u32 s68, s38, 3456
    buffer_load_dwordx4 a[12:15], v63, s[52:55], s68 offen offset:0 nt
    buffer_load_dwordx4 a[16:19], v63, s[52:55], s68 offen offset:256 nt
    buffer_load_dwordx4 a[20:23], v63, s[52:55], s68 offen offset:512 nt
    buffer_load_dwordx4 a[24:27], v63, s[52:55], s68 offen offset:768 nt
    buffer_load_dwordx4 a[28:31], v63, s[52:55], s68 offen offset:1024 nt
    ds_read_b64 v[16:17], v61 offset:128
    ds_read_b64 v[18:19], v61 offset:2432
    s_waitcnt lgkmcnt(0)
    v_and_b32 v24, v12, v16
    v_and_b32 v25, v13, v16
    v_and_b32 v26, v14, v16
    v_and_b32 v27, v15, v16
    v_and_b32 v28, v12, v18
    v_and_b32 v29, v13, v18
    v_and_b32 v30, v14, v18
    v_and_b32 v31, v15, v18
    s_waitcnt vmcnt(46)
    s_nop 0
    v_mfma_f32_16x16x32_bf16 v[32:35], v[24:27], a[32:35], v[32:35]
    v_mfma_f32_16x16x32_bf16 v[36:39], v[28:31], a[32:35], v[36:39]
    v_mfma_f32_16x16x32_bf16 v[40:43], v[24:27], a[36:39], v[40:43]
    v_mfma_f32_16x16x32_bf16 v[44:47], v[28:31], a[36:39], v[44:47]
    v_and_b32 v24, v12, v17
    v_and_b32 v25, v13, v17
    v_and_b32 v26, v14, v17
    v_and_b32 v27, v15, v17
    v_and_b32 v28, v12, v19
    v_and_b32 v29, v13, v19
    v_and_b32 v30, v14, v19
    v_and_b32 v31, v15, v19
    s_waitcnt vmcnt(44)
    s_nop 0
    v_mfma_f32_16x16x32_bf16 v[32:35], v[24:27], a[40:43], v[32:35]
    v_mfma_f32_16x16x32_bf16 v[36:39], v[28:31], a[40:43], v[36:39]
    v_mfma_f32_16x16x32_bf16 v[40:43], v[24:27], a[44:47], v[40:43]
    v_mfma_f32_16x16x32_bf16 v[44:47], v[28:31], a[44:47], v[44:47]
    ds_read_b64 v[16:17], v61 offset:192
    ds_read_b64 v[18:19], v61 offset:2496
    s_waitcnt lgkmcnt(0)
    v_and_b32 v24, v12, v16
    v_and_b32 v25, v13, v16
    v_and_b32 v26, v14, v16
    v_and_b32 v27, v15, v16
    v_and_b32 v28, v12, v18
    v_and_b32 v29, v13, v18
    v_and_b32 v30, v14, v18
    v_and_b32 v31, v15, v18
    s_waitcnt vmcnt(42)
    s_nop 0
    v_mfma_f32_16x16x32_bf16 v[32:35], v[24:27], a[48:51], v[32:35]
    v_mfma_f32_16x16x32_bf16 v[36:39], v[28:31], a[48:51], v[36:39]
    v_mfma_f32_16x16x32_bf16 v[40:43], v[24:27], a[52:55], v[40:43]
    v_mfma_f32_16x16x32_bf16 v[44:47], v[28:31], a[52:55], v[44:47]
    v_and_b32 v24, v12, v17
    v_and_b32 v25, v13, v17
    v_and_b32 v26, v14, v17
    v_and_b32 v27, v15, v17
    v_and_b32 v28, v12, v19
    v_and_b32 v29, v13, v19
    v_and_b32 v30, v14, v19
    v_and_b32 v31, v15, v19
    s_waitcnt vmcnt(40)
    s_nop 0
    v_mfma_f32_16x16x32_bf16 v[32:35], v[24:27], a[56:59], v[32:35]
    v_mfma_f32_16x16x32_bf16 v[36:39], v[28:31], a[56:59], v[36:39]
    v_mfma_f32_16x16x32_bf16 v[40:43], v[24:27], a[60:63], v[40:43]
    v_mfma_f32_16x16x32_bf16 v[44:47], v[28:31], a[60:63], v[44:47]
    ds_read_b64 v[16:17], v61 offset:256
    ds_read_b64 v[18:19], v61 offset:2560
    s_waitcnt lgkmcnt(0)
    v_and_b32 v24, v12, v16
    v_and_b32 v25, v13, v16
    v_and_b32 v26, v14, v16
    v_and_b32 v27, v15, v16
    v_and_b32 v28, v12, v18
    v_and_b32 v29, v13, v18
    v_and_b32 v30, v14, v18
    v_and_b32 v31, v15, v18
    s_waitcnt vmcnt(38)
    s_nop 0
    v_mfma_f32_16x16x32_bf16 v[32:35], v[24:27], a[64:67], v[32:35]
    v_mfma_f32_16x16x32_bf16 v[36:39], v[28:31], a[64:67], v[36:39]
    v_mfma_f32_16x16x32_bf16 v[40:43], v[24:27], a[68:71], v[40:43]
    v_mfma_f32_16x16x32_bf16 v[44:47], v[28:31], a[68:71], v[44:47]
    v_and_b32 v24, v12, v17
    v_and_b32 v25, v13, v17
    v_and_b32 v26, v14, v17
    v_and_b32 v27, v15, v17
    v_and_b32 v28, v12, v19
    v_and_b32 v29, v13, v19
    v_and_b32 v30, v14, v19
    v_and_b32 v31, v15, v19
    s_waitcnt vmcnt(36)
    s_nop 0
    v_mfma_f32_16x16x32_bf16 v[32:35], v[24:27], a[72:75], v[32:35]
    v_mfma_f32_16x16x32_bf16 v[36:39], v[28:31], a[72:75], v[36:39]
    v_mfma_f32_16x16x32_bf16 v[40:43], v[24:27], a[76:79], v[40:43]
    v_mfma_f32_16x16x32_bf16 v[44:47], v[28:31], a[76:79], v[44:47]
    ds_read_b64 v[16:17], v61 offset:320
    ds_read_b64 v[18:19], v61 offset:2624
    s_waitcnt lgkmcnt(0)
    v_and_b32 v24, v12, v16
    v_and_b32 v25, v13, v16
    v_and_b32 v26, v14, v16
    v_and_b32 v27, v15, v16
    v_and_b32 v28, v12, v18
    v_and_b32 v29, v13, v18
    v_and_b32 v30, v14, v18
    v_and_b32 v31, v15, v18
    s_waitcnt vmcnt(34)
    s_nop 0
    v_mfma_f32_16x16x32_bf16 v[32:35], v[24:27], a[80:83], v[32:35]
    v_mfma_f32_16x16x32_bf16 v[36:39], v[28:31], a[80:83], v[36:39]
    v_mfma_f32_16x16x32_bf16 v[40:43], v[24:27], a[84:87], v[40:43]
    v_mfma_f32_16x16x32_bf16 v[44:47], v[28:31], a[84:87], v[44:47]
    v_and_b32 v24, v12, v17
    v_and_b32 v25, v13, v17
    v_and_b32 v26, v14, v17
    v_and_b32 v27, v15, v17
    v_and_b32 v28, v12, v19
    v_and_b32 v29, v13, v19
    v_and_b32 v30, v14, v19
    v_and_b32 v31, v15, v19
    s_waitcnt vmcnt(32)
    s_nop 0
    v_mfma_f32_16x16x32_bf16 v[32:35], v[24:27], a[88:91], v[32:35]
    v_mfma_f32_16x16x32_bf16 v[36:39], v[28:31], a[88:91], v[36:39]
    v_mfma_f32_16x16x32_bf16 v[40:43], v[24:27], a[92:95], v[40:43]
    v_mfma_f32_16x16x32_bf16 v[44:47], v[28:31], a[92:95], v[44:47]
    ds_read_b64 v[16:17], v61 offset:384
    ds_read_b64 v[18:19], v61 offset:2688
    s_waitcnt lgkmcnt(0)
    v_and_b32 v24, v12, v16
    v_and_b32 v25, v13, v16
    v_and_b32 v26, v14, v16
    v_and_b32 v27, v15, v16
    v_and_b32 v28, v12, v18
    v_and_b32 v29, v13, v18
    v_and_b32 v30, v14, v18
    v_and_b32 v31, v15, v18
    s_waitcnt vmcnt(30)
    s_nop 0
    v_mfma_f32_16x16x32_bf16 v[32:35], v[24:27], a[96:99], v[32:35]
    v_mfma_f32_16x16x32_bf16 v[36:39], v[28:31], a[96:99], v[36:39]
    v_mfma_f32_16x16x32_bf16 v[40:43], v[24:27], a[100:103], v[40:43]
    v_mfma_f32_16x16x32_bf16 v[44:47], v[28:31], a[100:103], v[44:47]
    v_and_b32 v24, v12, v17
    v_and_b32 v25, v13, v17
    v_and_b32 v26, v14, v17
    v_and_b32 v27, v15, v17
    v_and_b32 v28, v12, v19
    v_and_b32 v29, v13, v19
    v_and_b32 v30, v14, v19
    v_and_b32 v31, v15, v19
    s_waitcnt vmcnt(28)
    s_nop 0
    v_mfma_f32_16x16x32_bf16 v[32:35], v[24:27], a[104:107], v[32:35]
    v_mfma_f32_16x16x32_bf16 v[36:39], v[28:31], a[104:107], v[36:39]
    v_mfma_f32_16x16x32_bf16 v[40:43], v[24:27], a[108:111], v[40:43]
    v_mfma_f32_16x16x32_bf16 v[44:47], v[28:31], a[108:111], v[44:47]
    ds_read_b64 v[16:17], v61 offset:448
    ds_read_b64 v[18:19], v61 offset:2752
    s_waitcnt lgkmcnt(0)
    v_and_b32 v24, v12, v16
    v_and_b32 v25, v13, v16
    v_and_b32 v26, v14, v16
    v_and_b32 v27, v15, v16
    v_and_b32 v28, v12, v18
    v_and_b32 v29, v13, v18
    v_and_b32 v30, v14, v18
    v_and_b32 v31, v15, v18
    s_waitcnt vmcnt(26)
    s_nop 0
    v_mfma_f32_16x16x32_bf16 v[32:35], v[24:27], a[112:115], v[32:35]
    v_mfma_f32_16x16x32_bf16 v[36:39], v[28:31], a[112:115], v[36:39]
    v_mfma_f32_16x16x32_bf16 v[40:43], v[24:27], a[116:119], v[40:43]
    v_mfma_f32_16x16x32_bf16 v[44:47], v[28:31], a[116:119], v[44:47]
    v_and_b32 v24, v12, v17
    v_and_b32 v25, v13, v17
    v_and_b32 v26, v14, v17
    v_and_b32 v27, v15, v17
    v_and_b32 v28, v12, v19
    v_and_b32 v29, v13, v19
    v_and_b32 v30, v14, v19
    v_and_b32 v31, v15, v19
    s_waitcnt vmcnt(24)
    s_nop 0
    v_mfma_f32_16x16x32_bf16 v[32:35], v[24:27], a[120:123], v[32:35]
    v_mfma_f32_16x16x32_bf16 v[36:39], v[28:31], a[120:123], v[36:39]
    v_mfma_f32_16x16x32_bf16 v[40:43], v[24:27], a[124:127], v[40:43]
    v_mfma_f32_16x16x32_bf16 v[44:47], v[28:31], a[124:127], v[44:47]
    ds_read_b64 v[16:17], v61 offset:512
    ds_read_b64 v[18:19], v61 offset:2816
    s_waitcnt lgkmcnt(0)
    v_and_b32 v24, v12, v16
    v_and_b32 v25, v13, v16
    v_and_b32 v26, v14, v16
    v_and_b32 v27, v15, v16
    v_and_b32 v28, v12, v18
    v_and_b32 v29, v13, v18
    v_and_b32 v30, v14, v18
    v_and_b32 v31, v15, v18
    s_waitcnt vmcnt(22)
    s_nop 0
    v_mfma_f32_16x16x32_bf16 v[32:35], v[24:27], a[128:131], v[32:35]
    v_mfma_f32_16x16x32_bf16 v[36:39], v[28:31], a[128:131], v[36:39]
    v_mfma_f32_16x16x32_bf16 v[40:43], v[24:27], a[132:135], v[40:43]
    v_mfma_f32_16x16x32_bf16 v[44:47], v[28:31], a[132:135], v[44:47]
    v_and_b32 v24, v12, v17
    v_and_b32 v25, v13, v17
    v_and_b32 v26, v14, v17
    v_and_b32 v27, v15, v17
    v_and_b32 v28, v12, v19
    v_and_b32 v29, v13, v19
    v_and_b32 v30, v14, v19
    v_and_b32 v31, v15, v19
    s_waitcnt vmcnt(20)
    s_nop 0
    v_mfma_f32_16x16x32_bf16 v[32:35], v[24:27], a[136:139], v[32:35]
    v_mfma_f32_16x16x32_bf16 v[36:39], v[28:31], a[136:139], v[36:39]
    v_mfma_f32_16x16x32_bf16 v[40:43], v[24:27], a[140:143], v[40:43]
    v_mfma_f32_16x16x32_bf16 v[44:47], v[28:31], a[140:143], v[44:47]
    v_bfe_u32 v50, v0, 3, 1
    v_lshlrev_b32 v50, 9, v50
    v_and_b32 v60, 7, v0
    v_lshl_add_u32 v50, v60, 5, v50
    v_bfe_u32 v60, v0, 4, 1
    v_lshl_add_u32 v50, v60, 4, v50
    s_lshl_b32 s35, s33, 10
    v_add_u32 v50, s35, v50
    s_mov_b32 exec_lo, 0x00ff00ff
    s_mov_b32 exec_hi, 0xff00ff00
    ds_write_b128 v50, v[32:35] offset:18560
    ds_write_b128 v50, v[36:39] offset:18816
    ds_write_b128 v50, v[40:43] offset:22656
    ds_write_b128 v50, v[44:47] offset:22912
    s_mov_b64 exec, -1
    s_waitcnt lgkmcnt(0)
    s_add_u32 s85, s85, 1
    s_lshl_b32 s35, s33, 2
    v_mov_b32 v8, s35
    v_mov_b32 v9, s85
    v_mov_b32 v10, 0
    s_waitcnt lgkmcnt(0)
    ds_write_b32 v8, v9 offset:9216
L_hsync_7:
    ds_read_b128 v[4:7], v10 offset:9216
    s_waitcnt lgkmcnt(0)
    v_min3_u32 v4, v4, v5, v6
    v_min_u32 v4, v4, v7
    v_cmp_gt_u32 vcc, s85, v4
    s_cbranch_vccnz L_hsync_7
    v_bfe_u32 v50, v0, 4, 1
    v_lshlrev_b32 v50, 8, v50
    v_and_b32 v60, 15, v0
    v_lshl_add_u32 v50, v60, 2, v50
    s_lshl_b32 s35, s33, 6
    v_add_u32 v50, s35, v50
    ds_read_b32 v16, v50 offset:18560
    ds_read_b32 v17, v50 offset:19072
    ds_read_b32 v18, v50 offset:19584
    ds_read_b32 v19, v50 offset:20096
    ds_read_b32 v20, v50 offset:20608
    ds_read_b32 v21, v50 offset:21120
    ds_read_b32 v22, v50 offset:21632
    ds_read_b32 v23, v50 offset:22144
    ds_read_b32 v24, v50 offset:22656
    ds_read_b32 v25, v50 offset:23168
    ds_read_b32 v26, v50 offset:23680
    ds_read_b32 v27, v50 offset:24192
    ds_read_b32 v28, v50 offset:24704
    ds_read_b32 v29, v50 offset:25216
    ds_read_b32 v30, v50 offset:25728
    ds_read_b32 v31, v50 offset:26240
    s_waitcnt lgkmcnt(0)
    v_add_f32 v16, v16, v17
    v_add_f32 v18, v18, v19
    v_add_f32 v20, v20, v21
    v_add_f32 v22, v22, v23
    v_add_f32 v16, v16, v18
    v_add_f32 v20, v20, v22
    v_add_f32 v16, v16, v20
    v_add_f32 v24, v24, v25
    v_add_f32 v26, v26, v27
    v_add_f32 v28, v28, v29
    v_add_f32 v30, v30, v31
    v_add_f32 v24, v24, v26
    v_add_f32 v28, v28, v30
    v_add_f32 v24, v24, v28
    v_cvt_pk_bf16_f32 v60, v16, v24
    v_lshlrev_b32 v16, 16, v60
    v_and_b32 v24, 0xffff0000, v60
    v_mul_f32 v48, v16, v16
    v_mul_f32 v48, v48, v16
    v_mul_f32 v48, 0x3d372713, v48
    v_add_f32 v48, v48, v16
    v_mul_f32 v48, 0xc0135761, v48
    v_exp_f32 v48, v48
    s_nop 0
    v_add_f32 v48, 1.0, v48
    v_rcp_f32 v48, v48
    s_nop 0
    v_mul_f32 v16, v16, v48
    v_cvt_pk_bf16_f32 v60, v16, v16
    v_and_b32 v16, 0xffff0000, v60
    v_mul_f32 v16, v16, v24
    v_cvt_pk_bf16_f32 v16, v16, v16
    ds_write_b32 v50, v16 offset:26752
    s_waitcnt lgkmcnt(0)
    v_bfe_u32 v61, v0, 3, 1
    v_lshlrev_b32 v61, 8, v61
    v_lshrrev_b32 v60, 4, v0
    v_lshl_add_u32 v61, v60, 4, v61
    s_lshl_b32 s35, s33, 6
    v_add_u32 v61, s35, v61
    ds_read_b128 v[16:19], v61 offset:26752
    s_waitcnt vmcnt(0) lgkmcnt(0)
    v_and_b32 v24, v12, v16
    v_and_b32 v25, v13, v16
    v_and_b32 v26, v14, v16
    v_and_b32 v27, v15, v16
    s_nop 1
    v_mfma_f32_16x16x32_bf16 v[32:35], v[24:27], a[144:147], 0
    v_mfma_f32_16x16x32_bf16 v[36:39], v[24:27], a[148:151], 0
    v_mfma_f32_16x16x32_bf16 v[40:43], v[24:27], a[152:155], 0
    v_mfma_f32_16x16x32_bf16 v[44:47], v[24:27], a[156:159], 0
    v_mfma_f32_16x16x32_bf16 v[48:51], v[24:27], a[160:163], 0
    v_and_b32 v28, v12, v17
    v_and_b32 v29, v13, v17
    v_and_b32 v30, v14, v17
    v_and_b32 v31, v15, v17
    s_nop 1
    v_mfma_f32_16x16x32_bf16 v[32:35], v[28:31], a[164:167], v[32:35]
    v_mfma_f32_16x16x32_bf16 v[36:39], v[28:31], a[168:171], v[36:39]
    v_mfma_f32_16x16x32_bf16 v[40:43], v[28:31], a[172:175], v[40:43]
    v_mfma_f32_16x16x32_bf16 v[44:47], v[28:31], a[176:179], v[44:47]
    v_mfma_f32_16x16x32_bf16 v[48:51], v[28:31], a[180:183], v[48:51]
    v_and_b32 v24, v12, v18
    v_and_b32 v25, v13, v18
    v_and_b32 v26, v14, v18
    v_and_b32 v27, v15, v18
    s_nop 1
    v_mfma_f32_16x16x32_bf16 v[32:35], v[24:27], a[184:187], v[32:35]
    v_mfma_f32_16x16x32_bf16 v[36:39], v[24:27], a[188:191], v[36:39]
    v_mfma_f32_16x16x32_bf16 v[40:43], v[24:27], a[0:3], v[40:43]
    v_mfma_f32_16x16x32_bf16 v[44:47], v[24:27], a[4:7], v[44:47]
    v_mfma_f32_16x16x32_bf16 v[48:51], v[24:27], a[8:11], v[48:51]
    v_and_b32 v28, v12, v19
    v_and_b32 v29, v13, v19
    v_and_b32 v30, v14, v19
    v_and_b32 v31, v15, v19
    s_nop 1
    v_mfma_f32_16x16x32_bf16 v[32:35], v[28:31], a[12:15], v[32:35]
    v_mfma_f32_16x16x32_bf16 v[36:39], v[28:31], a[16:19], v[36:39]
    v_mfma_f32_16x16x32_bf16 v[40:43], v[28:31], a[20:23], v[40:43]
    v_mfma_f32_16x16x32_bf16 v[44:47], v[28:31], a[24:27], v[44:47]
    v_mfma_f32_16x16x32_bf16 v[48:51], v[28:31], a[28:31], v[48:51]
    s_mul_i32 s67, s84, 9216
    s_add_u32 s67, s67, 2621440
    s_mul_i32 s35, s33, 5120
    v_add_u32 v60, s35, v62
    v_lshrrev_b32 v52, 5, v0
    v_and_b32 v53, 31, v0
    v_lshlrev_b32 v54, 9, v52
    v_lshl_add_u32 v54, v53, 4, v54
    s_lshl_b32 s36, s33, 10
    v_add_u32 v54, s36, v54
    v_mul_u32_u24 v55, 4608, v52
    v_lshl_add_u32 v55, v53, 5, v55
    ds_write_b128 v60, v[32:35] offset:27264
    ds_write_b128 v60, v[36:39] offset:28288
    ds_write_b128 v60, v[40:43] offset:29312
    ds_write_b128 v60, v[44:47] offset:30336
    ds_write_b128 v60, v[48:51] offset:31360
    v_bfe_u32 v52, v0, 4, 1
    v_and_b32 v53, 15, v0
    v_lshlrev_b32 v56, 9, v52
    v_lshl_add_u32 v56, v53, 4, v56
    v_mul_u32_u24 v57, 4608, v52
    v_lshl_add_u32 v57, v53, 5, v57
    s_add_u32 s37, s67, s36
    s_add_u32 s38, s67, 4096
    s_add_u32 s85, s85, 1
    s_lshl_b32 s35, s33, 2
    v_mov_b32 v8, s35
    v_mov_b32 v9, s85
    v_mov_b32 v10, 0
    s_waitcnt lgkmcnt(0)
    ds_write_b32 v8, v9 offset:9216
L_hsync_8:
    ds_read_b128 v[4:7], v10 offset:9216
    s_waitcnt lgkmcnt(0)
    v_min3_u32 v4, v4, v5, v6
    v_min_u32 v4, v4, v7
    v_cmp_gt_u32 vcc, s85, v4
    s_cbranch_vccnz L_hsync_8
    ds_read_b128 v[16:19], v54 offset:27264
    ds_read_b128 v[20:23], v54 offset:32384
    ds_read_b128 v[24:27], v54 offset:37504
    ds_read_b128 v[28:31], v54 offset:42624
    s_cmp_eq_u32 s33, 0
    s_cbranch_scc0 L_p5ay
    ds_read_b128 v[32:35], v56 offset:31360
    ds_read_b128 v[36:39], v56 offset:36480
    ds_read_b128 v[40:43], v56 offset:41600
    ds_read_b128 v[44:47], v56 offset:46720
L_p5ay:
    v_mov_b32 v5, s82
    v_mov_b32 v7, s82
    v_mov_b32 v9, s82
    v_mov_b32 v11, s82
    s_waitcnt lgkmcnt(0)
    v_pk_add_f32 v[16:17], v[16:17], v[20:21]
    v_pk_add_f32 v[24:25], v[24:25], v[28:29]
    v_pk_add_f32 v[18:19], v[18:19], v[22:23]
    v_pk_add_f32 v[26:27], v[26:27], v[30:31]
    v_add_f32 v4, v16, v24
    v_add_f32 v6, v17, v25
    v_add_f32 v8, v18, v26
    v_add_f32 v10, v19, v27
    buffer_store_dwordx4 v[4:7], v55, s[60:63], s37 offen sc1
    buffer_store_dwordx4 v[8:11], v55, s[60:63], s37 offen offset:16 sc1
    s_cmp_eq_u32 s33, 0
    s_cbranch_scc0 L_p5by
    s_mov_b32 exec_hi, 0
    s_nop 0
    v_pk_add_f32 v[32:33], v[32:33], v[36:37]
    v_pk_add_f32 v[40:41], v[40:41], v[44:45]
    v_pk_add_f32 v[34:35], v[34:35], v[38:39]
    v_pk_add_f32 v[42:43], v[42:43], v[46:47]
    v_add_f32 v4, v32, v40
    v_add_f32 v6, v33, v41
    v_add_f32 v8, v34, v42
    v_add_f32 v10, v35, v43
    buffer_store_dwordx4 v[4:7], v57, s[60:63], s38 offen sc1
    buffer_store_dwordx4 v[8:11], v57, s[60:63], s38 offen offset:16 sc1
    s_mov_b64 exec, -1
L_p5by:
    s_branch L_claim_next
L_notffn:
    s_cmp_ge_u32 s84, 104
    s_cbranch_scc1 L_notcons
    s_sub_u32 s39, s84, 72
    s_mov_b32 s48, s12
    s_mov_b32 s49, s13
    s_mov_b32 s50, 4718592
    s_mov_b32 s51, 0x20000
    v_lshrrev_b32 v2, 4, v0
    v_mul_u32_u24 v2, 4608, v2
    v_and_b32 v60, 15, v0
    v_lshl_add_u32 v2, v60, 4, v2
    s_lshl_b32 s67, s39, 7
    s_lshl_b32 s35, s33, 5
    s_add_u32 s67, s67, s35
    s_mul_i32 s67, s67, 1152
    s_add_u32 s68, s67, 0
    buffer_load_dwordx4 a[0:3], v2, s[48:51], s68 offen offset:0 nt
    buffer_load_dwordx4 a[4:7], v2, s[48:51], s68 offen offset:256 nt
    buffer_load_dwordx4 a[8:11], v2, s[48:51], s68 offen offset:512 nt
    buffer_load_dwordx4 a[12:15], v2, s[48:51], s68 offen offset:768 nt
    buffer_load_dwordx4 a[16:19], v2, s[48:51], s68 offen offset:1024 nt
    s_add_u32 s68, s67, 1152
    buffer_load_dwordx4 a[20:23], v2, s[48:51], s68 offen offset:0 nt
    buffer_load_dwordx4 a[24:27], v2, s[48:51], s68 offen offset:256 nt
    buffer_load_dwordx4 a[28:31], v2, s[48:51], s68 offen offset:512 nt
    buffer_load_dwordx4 a[32:35], v2, s[48:51], s68 offen offset:768 nt
    buffer_load_dwordx4 a[36:39], v2, s[48:51], s68 offen offset:1024 nt
    s_add_u32 s68, s67, 2304
    buffer_load_dwordx4 a[40:43], v2, s[48:51], s68 offen offset:0 nt
    buffer_load_dwordx4 a[44:47], v2, s[48:51], s68 offen offset:256 nt
    buffer_load_dwordx4 a[48:51], v2, s[48:51], s68 offen offset:512 nt
    buffer_load_dwordx4 a[52:55], v2, s[48:51], s68 offen offset:768 nt
    buffer_load_dwordx4 a[56:59], v2, s[48:51], s68 offen offset:1024 nt
    s_add_u32 s68, s67, 3456
    buffer_load_dwordx4 a[60:63], v2, s[48:51], s68 offen offset:0 nt
    buffer_load_dwordx4 a[64:67], v2, s[48:51], s68 offen offset:256 nt
    buffer_load_dwordx4 a[68:71], v2, s[48:51], s68 offen offset:512 nt
    buffer_load_dwordx4 a[72:75], v2, s[48:51], s68 offen offset:768 nt
    buffer_load_dwordx4 a[76:79], v2, s[48:51], s68 offen offset:1024 nt
    s_add_u32 s68, s67, 18432
    buffer_load_dwordx4 a[80:83], v2, s[48:51], s68 offen offset:0 nt
    buffer_load_dwordx4 a[84:87], v2, s[48:51], s68 offen offset:256 nt
    buffer_load_dwordx4 a[88:91], v2, s[48:51], s68 offen offset:512 nt
    buffer_load_dwordx4 a[92:95], v2, s[48:51], s68 offen offset:768 nt
    buffer_load_dwordx4 a[96:99], v2, s[48:51], s68 offen offset:1024 nt
    s_add_u32 s68, s67, 19584
    buffer_load_dwordx4 a[100:103], v2, s[48:51], s68 offen offset:0 nt
    buffer_load_dwordx4 a[104:107], v2, s[48:51], s68 offen offset:256 nt
    buffer_load_dwordx4 a[108:111], v2, s[48:51], s68 offen offset:512 nt
    buffer_load_dwordx4 a[112:115], v2, s[48:51], s68 offen offset:768 nt
    buffer_load_dwordx4 a[116:119], v2, s[48:51], s68 offen offset:1024 nt
    s_add_u32 s68, s67, 20736
    buffer_load_dwordx4 a[120:123], v2, s[48:51], s68 offen offset:0 nt
    buffer_load_dwordx4 a[124:127], v2, s[48:51], s68 offen offset:256 nt
    buffer_load_dwordx4 a[128:131], v2, s[48:51], s68 offen offset:512 nt
    buffer_load_dwordx4 a[132:135], v2, s[48:51], s68 offen offset:768 nt
    buffer_load_dwordx4 a[136:139], v2, s[48:51], s68 offen offset:1024 nt
    s_add_u32 s68, s67, 21888
    buffer_load_dwordx4 a[140:143], v2, s[48:51], s68 offen offset:0 nt
    buffer_load_dwordx4 a[144:147], v2, s[48:51], s68 offen offset:256 nt
    buffer_load_dwordx4 a[148:151], v2, s[48:51], s68 offen offset:512 nt
    buffer_load_dwordx4 a[152:155], v2, s[48:51], s68 offen offset:768 nt
    buffer_load_dwordx4 a[156:159], v2, s[48:51], s68 offen offset:1024 nt
    s_lshr_b32 s35, s39, 1
    s_lshl_b32 s35, s35, 1
    s_lshr_b32 s36, s33, 1
    s_add_u32 s35, s35, s36
    s_lshl_b32 s67, s35, 15
    s_add_u32 s67, s67, 1048576
    s_and_b32 s36, s39, 1
    s_lshl_b32 s37, s36, 10
    s_and_b32 s38, s33, 1
    s_lshl_b32 s38, s38, 9
    s_add_u32 s37, s37, s38
    v_lshlrev_b32 v36, 3, v0
    v_add_u32 v36, s37, v36
    s_lshl_b32 s36, s36, 4
    s_add_u32 s36, s36, 2048
    v_and_b32 v37, 7, v0
    v_lshlrev_b32 v37, 12, v37
    v_add_u32 v37, s36, v37
    s_lshl_b32 s36, s33, 8
    v_lshlrev_b32 v63, 2, v0
    v_add_u32 v63, s36, v63
    v_bfe_u32 v61, v0, 3, 1
    v_lshlrev_b32 v61, 9, v61
    v_lshrrev_b32 v50, 4, v0
    v_lshl_add_u32 v61, v50, 4, v61
    s_lshl_b32 s36, s33, 7
    v_add_u32 v61, s36, v61
    v_mov_b32 v10, 0
L_wflag_9:
    s_sleep 2
    ds_read_b128 v[4:7], v10 offset:9232
    s_waitcnt lgkmcnt(0)
    v_min3_u32 v4, v4, v5, v6
    v_min_u32 v4, v4, v7
    v_cmp_eq_u32 vcc, 0, v4
    s_cbranch_vccnz L_wflag_9
    s_mov_b32 s76, 0
    buffer_load_dwordx4 v[32:35], v37, s[60:63], s67 offen sc1
    s_add_u32 s36, s67, 0
    buffer_load_dwordx2 v[16:17], v36, s[60:63], s36 offen sc1
    s_add_u32 s36, s67, 4096
    buffer_load_dwordx2 v[18:19], v36, s[60:63], s36 offen sc1
    s_add_u32 s36, s67, 8192
    buffer_load_dwordx2 v[20:21], v36, s[60:63], s36 offen sc1
    s_add_u32 s36, s67, 12288
    buffer_load_dwordx2 v[22:23], v36, s[60:63], s36 offen sc1
    s_add_u32 s36, s67, 16384
    buffer_load_dwordx2 v[24:25], v36, s[60:63], s36 offen sc1
    s_add_u32 s36, s67, 20480
    buffer_load_dwordx2 v[26:27], v36, s[60:63], s36 offen sc1
    s_add_u32 s36, s67, 24576
    buffer_load_dwordx2 v[28:29], v36, s[60:63], s36 offen sc1
    s_add_u32 s36, s67, 28672
    buffer_load_dwordx2 v[30:31], v36, s[60:63], s36 offen sc1
    s_sleep 10
    buffer_load_dwordx4 v[56:59], v37, s[60:63], s67 offen sc1
    s_add_u32 s36, s67, 0
    buffer_load_dwordx2 v[40:41], v36, s[60:63], s36 offen sc1
    s_add_u32 s36, s67, 4096
    buffer_load_dwordx2 v[42:43], v36, s[60:63], s36 offen sc1
    s_add_u32 s36, s67, 8192
    buffer_load_dwordx2 v[44:45], v36, s[60:63], s36 offen sc1
    s_add_u32 s36, s67, 12288
    buffer_load_dwordx2 v[46:47], v36, s[60:63], s36 offen sc1
    s_add_u32 s36, s67, 16384
    buffer_load_dwordx2 v[48:49], v36, s[60:63], s36 offen sc1
    s_add_u32 s36, s67, 20480
    buffer_load_dwordx2 v[50:51], v36, s[60:63], s36 offen sc1
    s_add_u32 s36, s67, 24576
    buffer_load_dwordx2 v[52:53], v36, s[60:63], s36 offen sc1
    s_add_u32 s36, s67, 28672
    buffer_load_dwordx2 v[54:55], v36, s[60:63], s36 offen sc1
L_poll1:
    s_waitcnt vmcnt(9)
    v_sad_u32 v38, v33, s82, 0
    v_sad_u32 v38, v35, s82, v38
    v_sad_u32 v38, v17, s82, v38
    v_sad_u32 v38, v19, s82, v38
    v_sad_u32 v38, v21, s82, v38
    v_sad_u32 v38, v23, s82, v38
    v_sad_u32 v38, v25, s82, v38
    v_sad_u32 v38, v27, s82, v38
    v_sad_u32 v38, v29, s82, v38
    v_sad_u32 v38, v31, s82, v38
    v_cmp_ne_u32 vcc, 0, v38
    s_cbranch_vccz L_got1a
    s_add_u32 s76, s76, 1
    s_cmp_ge_u32 s76, 20000
    s_cbranch_scc1 L_got1a
    buffer_load_dwordx4 v[32:35], v37, s[60:63], s67 offen sc1
    s_add_u32 s36, s67, 0
    buffer_load_dwordx2 v[16:17], v36, s[60:63], s36 offen sc1
    s_add_u32 s36, s67, 4096
    buffer_load_dwordx2 v[18:19], v36, s[60:63], s36 offen sc1
    s_add_u32 s36, s67, 8192
    buffer_load_dwordx2 v[20:21], v36, s[60:63], s36 offen sc1
    s_add_u32 s36, s67, 12288
    buffer_load_dwordx2 v[22:23], v36, s[60:63], s36 offen sc1
    s_add_u32 s36, s67, 16384
    buffer_load_dwordx2 v[24:25], v36, s[60:63], s36 offen sc1
    s_add_u32 s36, s67, 20480
    buffer_load_dwordx2 v[26:27], v36, s[60:63], s36 offen sc1
    s_add_u32 s36, s67, 24576
    buffer_load_dwordx2 v[28:29], v36, s[60:63], s36 offen sc1
    s_add_u32 s36, s67, 28672
    buffer_load_dwordx2 v[30:31], v36, s[60:63], s36 offen sc1
    s_waitcnt vmcnt(9)
    v_sad_u32 v38, v57, s82, 0
    v_sad_u32 v38, v59, s82, v38
    v_sad_u32 v38, v41, s82, v38
    v_sad_u32 v38, v43, s82, v38
    v_sad_u32 v38, v45, s82, v38
    v_sad_u32 v38, v47, s82, v38
    v_sad_u32 v38, v49, s82, v38
    v_sad_u32 v38, v51, s82, v38
    v_sad_u32 v38, v53, s82, v38
    v_sad_u32 v38, v55, s82, v38
    v_cmp_ne_u32 vcc, 0, v38
    s_cbranch_vccz L_got1b
    buffer_load_dwordx4 v[56:59], v37, s[60:63], s67 offen sc1
    s_add_u32 s36, s67, 0
    buffer_load_dwordx2 v[40:41], v36, s[60:63], s36 offen sc1
    s_add_u32 s36, s67, 4096
    buffer_load_dwordx2 v[42:43], v36, s[60:63], s36 offen sc1
    s_add_u32 s36, s67, 8192
    buffer_load_dwordx2 v[44:45], v36, s[60:63], s36 offen sc1
    s_add_u32 s36, s67, 12288
    buffer_load_dwordx2 v[46:47], v36, s[60:63], s36 offen sc1
    s_add_u32 s36, s67, 16384
    buffer_load_dwordx2 v[48:49], v36, s[60:63], s36 offen sc1
    s_add_u32 s36, s67, 20480
    buffer_load_dwordx2 v[50:51], v36, s[60:63], s36 offen sc1
    s_add_u32 s36, s67, 24576
    buffer_load_dwordx2 v[52:53], v36, s[60:63], s36 offen sc1
    s_add_u32 s36, s67, 28672
    buffer_load_dwordx2 v[54:55], v36, s[60:63], s36 offen sc1
    s_branch L_poll1
L_got1b:
    v_mov_b32 v38, v56
    s_nop 1
    v_max_f32_dpp v38, v38, v38 quad_perm:[1,0,3,2] row_mask:0xf bank_mask:0xf
    s_nop 1
    v_max_f32_dpp v38, v38, v38 quad_perm:[2,3,0,1] row_mask:0xf bank_mask:0xf
    s_nop 1
    v_max_f32_dpp v38, v38, v38 row_half_mirror row_mask:0xf bank_mask:0xf
    v_sub_f32 v38, v56, v38
    v_mul_f32 v38, s34, v38
    v_exp_f32 v38, v38
    s_nop 0
    v_mul_f32 v39, v38, v58
    v_readlane_b32 s86, v38, 0
    v_readlane_b32 s87, v38, 1
    v_readlane_b32 s88, v38, 2
    v_readlane_b32 s89, v38, 3
    v_readlane_b32 s90, v38, 4
    v_readlane_b32 s91, v38, 5
    v_readlane_b32 s92, v38, 6
    v_readlane_b32 s93, v38, 7
    v_add_f32_dpp v39, v39, v39 quad_perm:[1,0,3,2] row_mask:0xf bank_mask:0xf
    s_nop 1
    v_add_f32_dpp v39, v39, v39 quad_perm:[2,3,0,1] row_mask:0xf bank_mask:0xf
    s_nop 1
    v_add_f32_dpp v39, v39, v39 row_half_mirror row_mask:0xf bank_mask:0xf
    s_nop 1
    v_mul_f32 v4, s86, v40
    v_fmac_f32 v4, s87, v42
    v_fmac_f32 v4, s88, v44
    v_fmac_f32 v4, s89, v46
    v_fmac_f32 v4, s90, v48
    v_fmac_f32 v4, s91, v50
    v_fmac_f32 v4, s92, v52
    v_fmac_f32 v4, s93, v54
    v_rcp_f32 v5, v39
    s_nop 0
    v_mul_f32 v6, v4, v5
    v_fma_f32 v7, -v6, v39, v4
    v_fmac_f32 v6, v7, v5
    v_cvt_pk_bf16_f32 v6, v6, v6
    ds_write_b32 v63, v6 offset:13440
    s_branch L_got1
L_got1a:
    v_mov_b32 v38, v32
    s_nop 1
    v_max_f32_dpp v38, v38, v38 quad_perm:[1,0,3,2] row_mask:0xf bank_mask:0xf
    s_nop 1
    v_max_f32_dpp v38, v38, v38 quad_perm:[2,3,0,1] row_mask:0xf bank_mask:0xf
    s_nop 1
    v_max_f32_dpp v38, v38, v38 row_half_mirror row_mask:0xf bank_mask:0xf
    v_sub_f32 v38, v32, v38
    v_mul_f32 v38, s34, v38
    v_exp_f32 v38, v38
    s_nop 0
    v_mul_f32 v39, v38, v34
    v_readlane_b32 s86, v38, 0
    v_readlane_b32 s87, v38, 1
    v_readlane_b32 s88, v38, 2
    v_readlane_b32 s89, v38, 3
    v_readlane_b32 s90, v38, 4
    v_readlane_b32 s91, v38, 5
    v_readlane_b32 s92, v38, 6
    v_readlane_b32 s93, v38, 7
    v_add_f32_dpp v39, v39, v39 quad_perm:[1,0,3,2] row_mask:0xf bank_mask:0xf
    s_nop 1
    v_add_f32_dpp v39, v39, v39 quad_perm:[2,3,0,1] row_mask:0xf bank_mask:0xf
    s_nop 1
    v_add_f32_dpp v39, v39, v39 row_half_mirror row_mask:0xf bank_mask:0xf
    s_nop 1
    v_mul_f32 v4, s86, v16
    v_fmac_f32 v4, s87, v18
    v_fmac_f32 v4, s88, v20
    v_fmac_f32 v4, s89, v22
    v_fmac_f32 v4, s90, v24
    v_fmac_f32 v4, s91, v26
    v_fmac_f32 v4, s92, v28
    v_fmac_f32 v4, s93, v30
    v_rcp_f32 v5, v39
    s_nop 0
    v_mul_f32 v6, v4, v5
    v_fma_f32 v7, -v6, v39, v4
    v_fmac_f32 v6, v7, v5
    v_cvt_pk_bf16_f32 v6, v6, v6
    ds_write_b32 v63, v6 offset:13440
L_got1:
    s_waitcnt vmcnt(0)
    s_add_u32 s85, s85, 1
    s_lshl_b32 s35, s33, 2
    v_mov_b32 v8, s35
    v_mov_b32 v9, s85
    v_mov_b32 v10, 0
    s_waitcnt lgkmcnt(0)
    ds_write_b32 v8, v9 offset:9216
L_hsync_10:
    ds_read_b128 v[4:7], v10 offset:9216
    s_waitcnt lgkmcnt(0)
    v_min3_u32 v4, v4, v5, v6
    v_min_u32 v4, v4, v7
    v_cmp_gt_u32 vcc, s85, v4
    s_cbranch_vccnz L_hsync_10
    ds_read_b128 v[16:19], v61 offset:13440
    ds_read_b128 v[20:23], v61 offset:13504
    s_waitcnt lgkmcnt(0)
    v_and_b32 v24, v12, v16
    v_and_b32 v25, v13, v16
    v_and_b32 v26, v14, v16
    v_and_b32 v27, v15, v16
    s_nop 1
    v_mfma_f32_16x16x32_bf16 v[32:35], v[24:27], a[0:3], 0
    v_mfma_f32_16x16x32_bf16 v[36:39], v[24:27], a[4:7], 0
    v_and_b32 v28, v12, v17
    v_and_b32 v29, v13, v17
    v_and_b32 v30, v14, v17
    v_and_b32 v31, v15, v17
    v_mfma_f32_16x16x32_bf16 v[40:43], v[24:27], a[8:11], 0
    v_mfma_f32_16x16x32_bf16 v[44:47], v[24:27], a[12:15], 0
    v_mfma_f32_16x16x32_bf16 v[48:51], v[24:27], a[16:19], 0
    v_mfma_f32_16x16x32_bf16 v[32:35], v[28:31], a[20:23], v[32:35]
    v_mfma_f32_16x16x32_bf16 v[36:39], v[28:31], a[24:27], v[36:39]
    v_and_b32 v24, v12, v18
    v_and_b32 v25, v13, v18
    v_and_b32 v26, v14, v18
    v_and_b32 v27, v15, v18
    v_mfma_f32_16x16x32_bf16 v[40:43], v[28:31], a[28:31], v[40:43]
    v_mfma_f32_16x16x32_bf16 v[44:47], v[28:31], a[32:35], v[44:47]
    v_mfma_f32_16x16x32_bf16 v[48:51], v[28:31], a[36:39], v[48:51]
    v_mfma_f32_16x16x32_bf16 v[32:35], v[24:27], a[40:43], v[32:35]
    v_mfma_f32_16x16x32_bf16 v[36:39], v[24:27], a[44:47], v[36:39]
    v_and_b32 v28, v12, v19
    v_and_b32 v29, v13, v19
    v_and_b32 v30, v14, v19
    v_and_b32 v31, v15, v19
    v_mfma_f32_16x16x32_bf16 v[40:43], v[24:27], a[48:51], v[40:43]
    v_mfma_f32_16x16x32_bf16 v[44:47], v[24:27], a[52:55], v[44:47]
    v_mfma_f32_16x16x32_bf16 v[48:51], v[24:27], a[56:59], v[48:51]
    v_mfma_f32_16x16x32_bf16 v[32:35], v[28:31], a[60:63], v[32:35]
    v_mfma_f32_16x16x32_bf16 v[36:39], v[28:31], a[64:67], v[36:39]
    v_and_b32 v24, v12, v20
    v_and_b32 v25, v13, v20
    v_and_b32 v26, v14, v20
    v_and_b32 v27, v15, v20
    v_mfma_f32_16x16x32_bf16 v[40:43], v[28:31], a[68:71], v[40:43]
    v_mfma_f32_16x16x32_bf16 v[44:47], v[28:31], a[72:75], v[44:47]
    v_mfma_f32_16x16x32_bf16 v[48:51], v[28:31], a[76:79], v[48:51]
    v_mfma_f32_16x16x32_bf16 v[32:35], v[24:27], a[80:83], v[32:35]
    v_mfma_f32_16x16x32_bf16 v[36:39], v[24:27], a[84:87], v[36:39]
    v_and_b32 v28, v12, v21
    v_and_b32 v29, v13, v21
    v_and_b32 v30, v14, v21
    v_and_b32 v31, v15, v21
    v_mfma_f32_16x16x32_bf16 v[40:43], v[24:27], a[88:91], v[40:43]
    v_mfma_f32_16x16x32_bf16 v[44:47], v[24:27], a[92:95], v[44:47]
    v_mfma_f32_16x16x32_bf16 v[48:51], v[24:27], a[96:99], v[48:51]
    v_mfma_f32_16x16x32_bf16 v[32:35], v[28:31], a[100:103], v[32:35]
    v_mfma_f32_16x16x32_bf16 v[36:39], v[28:31], a[104:107], v[36:39]
    v_and_b32 v24, v12, v22
    v_and_b32 v25, v13, v22
    v_and_b32 v26, v14, v22
    v_and_b32 v27, v15, v22
    v_mfma_f32_16x16x32_bf16 v[40:43], v[28:31], a[108:111], v[40:43]
    v_mfma_f32_16x16x32_bf16 v[44:47], v[28:31], a[112:115], v[44:47]
    v_mfma_f32_16x16x32_bf16 v[48:51], v[28:31], a[116:119], v[48:51]
    v_mfma_f32_16x16x32_bf16 v[32:35], v[24:27], a[120:123], v[32:35]
    v_mfma_f32_16x16x32_bf16 v[36:39], v[24:27], a[124:127], v[36:39]
    v_and_b32 v28, v12, v23
    v_and_b32 v29, v13, v23
    v_and_b32 v30, v14, v23
    v_and_b32 v31, v15, v23
    v_mfma_f32_16x16x32_bf16 v[40:43], v[24:27], a[128:131], v[40:43]
    v_mfma_f32_16x16x32_bf16 v[44:47], v[24:27], a[132:135], v[44:47]
    v_mfma_f32_16x16x32_bf16 v[48:51], v[24:27], a[136:139], v[48:51]
    v_mfma_f32_16x16x32_bf16 v[32:35], v[28:31], a[140:143], v[32:35]
    v_mfma_f32_16x16x32_bf16 v[36:39], v[28:31], a[144:147], v[36:39]
    v_mfma_f32_16x16x32_bf16 v[40:43], v[28:31], a[148:151], v[40:43]
    v_mfma_f32_16x16x32_bf16 v[44:47], v[28:31], a[152:155], v[44:47]
    v_mfma_f32_16x16x32_bf16 v[48:51], v[28:31], a[156:159], v[48:51]
    s_mul_i32 s67, s39, 9216
    s_add_u32 s67, s67, 2097152
    s_mul_i32 s35, s33, 5120
    v_add_u32 v60, s35, v62
    v_lshrrev_b32 v52, 5, v0
    v_and_b32 v53, 31, v0
    v_lshlrev_b32 v54, 9, v52
    v_lshl_add_u32 v54, v53, 4, v54
    s_lshl_b32 s36, s33, 10
    v_add_u32 v54, s36, v54
    v_mul_u32_u24 v55, 4608, v52
    v_lshl_add_u32 v55, v53, 5, v55
    ds_write_b128 v60, v[32:35] offset:27264
    ds_write_b128 v60, v[36:39] offset:28288
    ds_write_b128 v60, v[40:43] offset:29312
    ds_write_b128 v60, v[44:47] offset:30336
    ds_write_b128 v60, v[48:51] offset:31360
    v_bfe_u32 v52, v0, 4, 1
    v_and_b32 v53, 15, v0
    v_lshlrev_b32 v56, 9, v52
    v_lshl_add_u32 v56, v53, 4, v56
    v_mul_u32_u24 v57, 4608, v52
    v_lshl_add_u32 v57, v53, 5, v57
    s_add_u32 s37, s67, s36
    s_add_u32 s38, s67, 4096
    s_add_u32 s85, s85, 1
    s_lshl_b32 s35, s33, 2
    v_mov_b32 v8, s35
    v_mov_b32 v9, s85
    v_mov_b32 v10, 0
    s_waitcnt lgkmcnt(0)
    ds_write_b32 v8, v9 offset:9216
L_hsync_11:
    ds_read_b128 v[4:7], v10 offset:9216
    s_waitcnt lgkmcnt(0)
    v_min3_u32 v4, v4, v5, v6
    v_min_u32 v4, v4, v7
    v_cmp_gt_u32 vcc, s85, v4
    s_cbranch_vccnz L_hsync_11
    ds_read_b128 v[16:19], v54 offset:27264
    ds_read_b128 v[20:23], v54 offset:32384
    ds_read_b128 v[24:27], v54 offset:37504
    ds_read_b128 v[28:31], v54 offset:42624
    s_cmp_eq_u32 s33, 0
    s_cbranch_scc0 L_p5as
    ds_read_b128 v[32:35], v56 offset:31360
    ds_read_b128 v[36:39], v56 offset:36480
    ds_read_b128 v[40:43], v56 offset:41600
    ds_read_b128 v[44:47], v56 offset:46720
L_p5as:
    v_mov_b32 v5, s82
    v_mov_b32 v7, s82
    v_mov_b32 v9, s82
    v_mov_b32 v11, s82
    s_waitcnt lgkmcnt(0)
    v_pk_add_f32 v[16:17], v[16:17], v[20:21]
    v_pk_add_f32 v[24:25], v[24:25], v[28:29]
    v_pk_add_f32 v[18:19], v[18:19], v[22:23]
    v_pk_add_f32 v[26:27], v[26:27], v[30:31]
    v_add_f32 v4, v16, v24
    v_add_f32 v6, v17, v25
    v_add_f32 v8, v18, v26
    v_add_f32 v10, v19, v27
    buffer_store_dwordx4 v[4:7], v55, s[60:63], s37 offen sc1
    buffer_store_dwordx4 v[8:11], v55, s[60:63], s37 offen offset:16 sc1
    s_cmp_eq_u32 s33, 0
    s_cbranch_scc0 L_p5bs
    s_mov_b32 exec_hi, 0
    s_nop 0
    v_pk_add_f32 v[32:33], v[32:33], v[36:37]
    v_pk_add_f32 v[40:41], v[40:41], v[44:45]
    v_pk_add_f32 v[34:35], v[34:35], v[38:39]
    v_pk_add_f32 v[42:43], v[42:43], v[46:47]
    v_add_f32 v4, v32, v40
    v_add_f32 v6, v33, v41
    v_add_f32 v8, v34, v42
    v_add_f32 v10, v35, v43
    buffer_store_dwordx4 v[4:7], v57, s[60:63], s38 offen sc1
    buffer_store_dwordx4 v[8:11], v57, s[60:63], s38 offen offset:16 sc1
    s_mov_b64 exec, -1
L_p5bs:
    s_branch L_hdone
L_notcons:
    s_cmp_ge_u32 s84, 122
    s_cbranch_scc1 L_hdone
    s_sub_u32 s74, s84, 104
    s_cmp_ge_u32 s74, 9
    s_cselect_b32 s35, 1, 0
    s_mul_i32 s36, s35, 9
    s_sub_u32 s36, s74, s36
    s_mul_i32 s37, s35, 576
    s_lshl_b32 s38, s36, 6
    s_add_u32 s37, s37, s38
    s_lshl_b32 s67, s37, 3
    s_lshl_b32 s68, s37, 1
    s_mov_b32 s44, s4
    s_mov_b32 s45, s5
    s_mov_b32 s46, 2304
    s_mov_b32 s47, 0x20000
    s_mov_b32 s48, s22
    s_mov_b32 s49, s23
    s_mov_b32 s50, 2304
    s_mov_b32 s51, 0x20000
    v_lshlrev_b32 v1, 3, v0
    v_lshlrev_b32 v2, 1, v0
    buffer_load_ushort v63, v2, s[44:47], s68 offen
    v_lshlrev_b32 v61, 2, v0
    s_lshl_b32 s35, s33, 8
    v_add_u32 v62, s35, v61
    s_mul_i32 s64, s33, 165888
    s_add_u32 s64, s64, s67
    s_add_u32 s64, s64, 2621440
    s_mul_i32 s65, s33, 73728
    s_add_u32 s65, s65, s67
    s_add_u32 s65, s65, 2097152
    v_mov_b32 v10, 0
L_wflag_12:
    s_sleep 2
    ds_read_b128 v[4:7], v10 offset:9232
    s_waitcnt lgkmcnt(0)
    v_min3_u32 v4, v4, v5, v6
    v_min_u32 v4, v4, v7
    v_cmp_eq_u32 vcc, 0, v4
    s_cbranch_vccnz L_wflag_12
    s_mov_b32 s76, 0
    s_mov_b32 s69, 0
L_pollf:
    s_bitcmp1_b32 s69, 4
    s_cbranch_scc1 L_f_ph2
    s_bitcmp1_b32 s69, 1
    s_cbranch_scc1 L_f_ni0
    s_add_u32 s35, s64, 0
    buffer_load_dwordx2 v[16:17], v1, s[60:63], s35 offen sc1
    s_add_u32 s35, s64, 9216
    buffer_load_dwordx2 v[18:19], v1, s[60:63], s35 offen sc1
    s_add_u32 s35, s64, 18432
    buffer_load_dwordx2 v[20:21], v1, s[60:63], s35 offen sc1
    s_add_u32 s35, s64, 27648
    buffer_load_dwordx2 v[22:23], v1, s[60:63], s35 offen sc1
    s_add_u32 s35, s64, 36864
    buffer_load_dwordx2 v[24:25], v1, s[60:63], s35 offen sc1
    s_add_u32 s35, s64, 46080
    buffer_load_dwordx2 v[26:27], v1, s[60:63], s35 offen sc1
L_f_ni0:
    s_bitcmp1_b32 s69, 2
    s_cbranch_scc1 L_f_ni1
    s_add_u32 s35, s64, 55296
    buffer_load_dwordx2 v[28:29], v1, s[60:63], s35 offen sc1
    s_add_u32 s35, s64, 64512
    buffer_load_dwordx2 v[30:31], v1, s[60:63], s35 offen sc1
    s_add_u32 s35, s64, 73728
    buffer_load_dwordx2 v[32:33], v1, s[60:63], s35 offen sc1
    s_add_u32 s35, s64, 82944
    buffer_load_dwordx2 v[34:35], v1, s[60:63], s35 offen sc1
    s_add_u32 s35, s64, 92160
    buffer_load_dwordx2 v[36:37], v1, s[60:63], s35 offen sc1
    s_add_u32 s35, s64, 101376
    buffer_load_dwordx2 v[38:39], v1, s[60:63], s35 offen sc1
L_f_ni1:
    s_bitcmp1_b32 s69, 3
    s_cbranch_scc1 L_f_ni2
    s_add_u32 s35, s64, 110592
    buffer_load_dwordx2 v[40:41], v1, s[60:63], s35 offen sc1
    s_add_u32 s35, s64, 119808
    buffer_load_dwordx2 v[42:43], v1, s[60:63], s35 offen sc1
    s_add_u32 s35, s64, 129024
    buffer_load_dwordx2 v[44:45], v1, s[60:63], s35 offen sc1
    s_add_u32 s35, s64, 138240
    buffer_load_dwordx2 v[46:47], v1, s[60:63], s35 offen sc1
    s_add_u32 s35, s64, 147456
    buffer_load_dwordx2 v[48:49], v1, s[60:63], s35 offen sc1
    s_add_u32 s35, s64, 156672
    buffer_load_dwordx2 v[50:51], v1, s[60:63], s35 offen sc1
L_f_ni2:
L_f_noy:
    s_bitcmp1_b32 s69, 0
    s_cbranch_scc1 L_f_nos
    s_add_u32 s35, s65, 0
    buffer_load_dwordx2 v[4:5], v1, s[60:63], s35 offen sc1
    s_add_u32 s35, s65, 9216
    buffer_load_dwordx2 v[6:7], v1, s[60:63], s35 offen sc1
    s_add_u32 s35, s65, 18432
    buffer_load_dwordx2 v[8:9], v1, s[60:63], s35 offen sc1
    s_add_u32 s35, s65, 27648
    buffer_load_dwordx2 v[10:11], v1, s[60:63], s35 offen sc1
    s_add_u32 s35, s65, 36864
    buffer_load_dwordx2 v[52:53], v1, s[60:63], s35 offen sc1
    s_add_u32 s35, s65, 46080
    buffer_load_dwordx2 v[54:55], v1, s[60:63], s35 offen sc1
    s_add_u32 s35, s65, 55296
    buffer_load_dwordx2 v[56:57], v1, s[60:63], s35 offen sc1
    s_add_u32 s35, s65, 64512
    buffer_load_dwordx2 v[58:59], v1, s[60:63], s35 offen sc1
L_f_nos:
    s_waitcnt vmcnt(0)
    s_bitcmp1_b32 s69, 0
    s_cbranch_scc1 L_f_chky
    v_sad_u32 v60, v5, s82, 0
    v_sad_u32 v60, v7, s82, v60
    v_sad_u32 v60, v9, s82, v60
    v_sad_u32 v60, v11, s82, v60
    v_sad_u32 v60, v53, s82, v60
    v_sad_u32 v60, v55, s82, v60
    v_sad_u32 v60, v57, s82, v60
    v_sad_u32 v60, v59, s82, v60
    v_cmp_ne_u32 vcc, 0, v60
    s_cbranch_vccnz L_f_chky
    v_add_f32 v4, v4, v6
    v_add_f32 v8, v8, v10
    v_add_f32 v52, v52, v54
    v_add_f32 v56, v56, v58
    v_add_f32 v4, v4, v8
    v_add_f32 v52, v52, v56
    v_add_f32 v4, v4, v52
    ds_write_b32 v62, v4 offset:48768
    s_or_b32 s69, s69, 1
L_f_chky:
    s_bitcmp1_b32 s69, 4
    s_cbranch_scc1 L_f_next
    s_bitcmp1_b32 s69, 1
    s_cbranch_scc1 L_f_nc0
    v_sad_u32 v60, v17, s82, 0
    v_sad_u32 v60, v19, s82, v60
    v_sad_u32 v60, v21, s82, v60
    v_sad_u32 v60, v23, s82, v60
    v_sad_u32 v60, v25, s82, v60
    v_sad_u32 v60, v27, s82, v60
    v_cmp_ne_u32 vcc, 0, v60
    s_cbranch_vccnz L_f_nc0
    s_or_b32 s69, s69, 2
L_f_nc0:
    s_bitcmp1_b32 s69, 2
    s_cbranch_scc1 L_f_nc1
    v_sad_u32 v60, v29, s82, 0
    v_sad_u32 v60, v31, s82, v60
    v_sad_u32 v60, v33, s82, v60
    v_sad_u32 v60, v35, s82, v60
    v_sad_u32 v60, v37, s82, v60
    v_sad_u32 v60, v39, s82, v60
    v_cmp_ne_u32 vcc, 0, v60
    s_cbranch_vccnz L_f_nc1
    s_or_b32 s69, s69, 4
L_f_nc1:
    s_bitcmp1_b32 s69, 3
    s_cbranch_scc1 L_f_nc2
    v_sad_u32 v60, v41, s82, 0
    v_sad_u32 v60, v43, s82, v60
    v_sad_u32 v60, v45, s82, v60
    v_sad_u32 v60, v47, s82, v60
    v_sad_u32 v60, v49, s82, v60
    v_sad_u32 v60, v51, s82, v60
    v_cmp_ne_u32 vcc, 0, v60
    s_cbranch_vccnz L_f_nc2
    s_or_b32 s69, s69, 8
L_f_nc2:
    s_and_b32 s35, s69, 14
    s_cmp_eq_u32 s35, 14
    s_cbranch_scc0 L_f_next
    v_add_f32 v16, v16, v18
    v_add_f32 v20, v20, v22
    v_add_f32 v24, v24, v26
    v_add_f32 v28, v28, v30
    v_add_f32 v32, v32, v34
    v_add_f32 v36, v36, v38
    v_add_f32 v40, v40, v42
    v_add_f32 v44, v44, v46
    v_add_f32 v48, v48, v50
    v_add_f32 v16, v16, v20
    v_add_f32 v24, v24, v28
    v_add_f32 v32, v32, v36
    v_add_f32 v40, v40, v44
    v_add_f32 v16, v16, v24
    v_add_f32 v32, v32, v40
    v_add_f32 v16, v16, v32
    v_add_f32 v16, v16, v48
    ds_write_b32 v62, v16 offset:47744
    s_or_b32 s69, s69, 16
L_f_next:
    s_and_b32 s35, s69, 17
    s_cmp_eq_u32 s35, 17
    s_cbranch_scc1 L_f_got
    s_add_u32 s76, s76, 1
    s_cmp_lt_u32 s76, 20000
    s_cbranch_scc1 L_pollf
    s_branch L_f_got
L_f_ph2:
    s_add_u32 s35, s65, 0
    buffer_load_dwordx2 v[32:33], v1, s[60:63], s35 offen sc1
    s_add_u32 s35, s65, 9216
    buffer_load_dwordx2 v[34:35], v1, s[60:63], s35 offen sc1
    s_add_u32 s35, s65, 18432
    buffer_load_dwordx2 v[36:37], v1, s[60:63], s35 offen sc1
    s_add_u32 s35, s65, 27648
    buffer_load_dwordx2 v[38:39], v1, s[60:63], s35 offen sc1
    s_add_u32 s35, s65, 36864
    buffer_load_dwordx2 v[40:41], v1, s[60:63], s35 offen sc1
    s_add_u32 s35, s65, 46080
    buffer_load_dwordx2 v[42:43], v1, s[60:63], s35 offen sc1
    s_add_u32 s35, s65, 55296
    buffer_load_dwordx2 v[44:45], v1, s[60:63], s35 offen sc1
    s_add_u32 s35, s65, 64512
    buffer_load_dwordx2 v[46:47], v1, s[60:63], s35 offen sc1
    s_sleep 10
    s_add_u32 s35, s65, 0
    buffer_load_dwordx2 v[48:49], v1, s[60:63], s35 offen sc1
    s_add_u32 s35, s65, 9216
    buffer_load_dwordx2 v[50:51], v1, s[60:63], s35 offen sc1
    s_add_u32 s35, s65, 18432
    buffer_load_dwordx2 v[52:53], v1, s[60:63], s35 offen sc1
    s_add_u32 s35, s65, 27648
    buffer_load_dwordx2 v[54:55], v1, s[60:63], s35 offen sc1
    s_add_u32 s35, s65, 36864
    buffer_load_dwordx2 v[56:57], v1, s[60:63], s35 offen sc1
    s_add_u32 s35, s65, 46080
    buffer_load_dwordx2 v[58:59], v1, s[60:63], s35 offen sc1
    s_add_u32 s35, s65, 55296
    buffer_load_dwordx2 v[12:13], v1, s[60:63], s35 offen sc1
    s_add_u32 s35, s65, 64512
    buffer_load_dwordx2 v[14:15], v1, s[60:63], s35 offen sc1
L_f_p2loop:
    s_waitcnt vmcnt(8)
    v_sad_u32 v60, v33, s82, 0
    v_sad_u32 v60, v35, s82, v60
    v_sad_u32 v60, v37, s82, v60
    v_sad_u32 v60, v39, s82, v60
    v_sad_u32 v60, v41, s82, v60
    v_sad_u32 v60, v43, s82, v60
    v_sad_u32 v60, v45, s82, v60
    v_sad_u32 v60, v47, s82, v60
    v_cmp_ne_u32 vcc, 0, v60
    s_cbranch_vccz L_f_p2a
    s_add_u32 s76, s76, 1
    s_cmp_ge_u32 s76, 20000
    s_cbranch_scc1 L_f_p2a
    s_add_u32 s35, s65, 0
    buffer_load_dwordx2 v[32:33], v1, s[60:63], s35 offen sc1
    s_add_u32 s35, s65, 9216
    buffer_load_dwordx2 v[34:35], v1, s[60:63], s35 offen sc1
    s_add_u32 s35, s65, 18432
    buffer_load_dwordx2 v[36:37], v1, s[60:63], s35 offen sc1
    s_add_u32 s35, s65, 27648
    buffer_load_dwordx2 v[38:39], v1, s[60:63], s35 offen sc1
    s_add_u32 s35, s65, 36864
    buffer_load_dwordx2 v[40:41], v1, s[60:63], s35 offen sc1
    s_add_u32 s35, s65, 46080
    buffer_load_dwordx2 v[42:43], v1, s[60:63], s35 offen sc1
    s_add_u32 s35, s65, 55296
    buffer_load_dwordx2 v[44:45], v1, s[60:63], s35 offen sc1
    s_add_u32 s35, s65, 64512
    buffer_load_dwordx2 v[46:47], v1, s[60:63], s35 offen sc1
    s_waitcnt vmcnt(8)
    v_sad_u32 v60, v49, s82, 0
    v_sad_u32 v60, v51, s82, v60
    v_sad_u32 v60, v53, s82, v60
    v_sad_u32 v60, v55, s82, v60
    v_sad_u32 v60, v57, s82, v60
    v_sad_u32 v60, v59, s82, v60
    v_sad_u32 v60, v13, s82, v60
    v_sad_u32 v60, v15, s82, v60
    v_cmp_ne_u32 vcc, 0, v60
    s_cbranch_vccz L_f_p2b
    s_add_u32 s35, s65, 0
    buffer_load_dwordx2 v[48:49], v1, s[60:63], s35 offen sc1
    s_add_u32 s35, s65, 9216
    buffer_load_dwordx2 v[50:51], v1, s[60:63], s35 offen sc1
    s_add_u32 s35, s65, 18432
    buffer_load_dwordx2 v[52:53], v1, s[60:63], s35 offen sc1
    s_add_u32 s35, s65, 27648
    buffer_load_dwordx2 v[54:55], v1, s[60:63], s35 offen sc1
    s_add_u32 s35, s65, 36864
    buffer_load_dwordx2 v[56:57], v1, s[60:63], s35 offen sc1
    s_add_u32 s35, s65, 46080
    buffer_load_dwordx2 v[58:59], v1, s[60:63], s35 offen sc1
    s_add_u32 s35, s65, 55296
    buffer_load_dwordx2 v[12:13], v1, s[60:63], s35 offen sc1
    s_add_u32 s35, s65, 64512
    buffer_load_dwordx2 v[14:15], v1, s[60:63], s35 offen sc1
    s_branch L_f_p2loop
L_f_p2b:
    v_add_f32 v48, v48, v50
    v_add_f32 v52, v52, v54
    v_add_f32 v56, v56, v58
    v_add_f32 v12, v12, v14
    v_add_f32 v48, v48, v52
    v_add_f32 v56, v56, v12
    v_add_f32 v48, v48, v56
    ds_write_b32 v62, v48 offset:48768
    s_branch L_f_got
L_f_p2a:
    v_add_f32 v32, v32, v34
    v_add_f32 v36, v36, v38
    v_add_f32 v40, v40, v42
    v_add_f32 v44, v44, v46
    v_add_f32 v32, v32, v36
    v_add_f32 v40, v40, v44
    v_add_f32 v32, v32, v40
    ds_write_b32 v62, v32 offset:48768
L_f_got:
    s_add_u32 s85, s85, 1
    s_lshl_b32 s35, s33, 2
    v_mov_b32 v8, s35
    v_mov_b32 v9, s85
    v_mov_b32 v10, 0
    s_waitcnt lgkmcnt(0)
    ds_write_b32 v8, v9 offset:9216
L_hsync_13:
    ds_read_b128 v[4:7], v10 offset:9216
    s_waitcnt lgkmcnt(0)
    v_min3_u32 v4, v4, v5, v6
    v_min_u32 v4, v4, v7
    v_cmp_gt_u32 vcc, s85, v4
    s_cbranch_vccnz L_hsync_13
    s_cmp_eq_u32 s33, 0
    s_cbranch_scc0 L_hdone
    ds_read_b32 v16, v61 offset:47744
    ds_read_b32 v17, v61 offset:48000
    ds_read_b32 v18, v61 offset:48256
    ds_read_b32 v19, v61 offset:48512
    ds_read_b32 v24, v61 offset:48768
    ds_read_b32 v25, v61 offset:49024
    ds_read_b32 v26, v61 offset:49280
    ds_read_b32 v27, v61 offset:49536
    s_waitcnt lgkmcnt(0)
    v_add_f32 v16, v16, v17
    v_add_f32 v18, v18, v19
    v_add_f32 v24, v24, v25
    v_add_f32 v26, v26, v27
    v_add_f32 v20, v16, v18
    v_add_f32 v28, v24, v26
    v_cvt_pk_bf16_f32 v21, v20, v28
    v_lshlrev_b32 v20, 16, v21
    v_and_b32 v28, 0xffff0000, v21
    v_mul_f32 v21, s34, v20
    v_sub_f32 v21, 0, v21
    v_exp_f32 v21, v21
    v_lshlrev_b32 v18, 16, v63
    v_add_f32 v21, 1.0, v21
    v_rcp_f32 v21, v21
    s_nop 0
    v_mul_f32 v20, v20, v21
    v_cvt_pk_bf16_f32 v21, v20, v20
    v_and_b32 v20, 0xffff0000, v21
    v_mul_f32 v20, v28, v20
    v_cvt_pk_bf16_f32 v21, v20, v20
    v_and_b32 v20, 0xffff0000, v21
    v_add_f32 v20, v18, v20
    v_cvt_pk_bf16_f32 v20, v20, v20
    buffer_store_short v20, v2, s[48:51], s68 offen sc1
    s_cmp_eq_u32 s74, 0
    s_cbranch_scc0 L_noepoch
    v_mov_b32 v22, s82
    v_mov_b32 v23, 0
    s_mov_b64 exec, 1
    buffer_store_dword v22, v23, s[60:63], 0 offen offset:0 sc1
    s_mov_b64 exec, -1
L_noepoch:
L_hdone:
    s_endpgm
L_roles_end:
L_helper:
    s_setprio 2
    s_mov_b32 s44, s4
    s_mov_b32 s45, s5
    s_mov_b32 s46, 2304
    s_mov_b32 s47, 0x20000
    v_mov_b32 v59, 0
    buffer_load_dword v25, v59, s[60:63], 0 offen offset:0 sc1
    v_lshrrev_b32 v1, 5, v0
    v_mul_u32_u24 v1, 1152, v1
    v_and_b32 v2, 31, v0
    v_lshl_add_u32 v1, v2, 2, v1
    buffer_load_dword v16, v1, s[44:47], 0 offen offset:0
    buffer_load_dword v17, v1, s[44:47], 0 offen offset:128
    buffer_load_dword v18, v1, s[44:47], 0 offen offset:256
    buffer_load_dword v19, v1, s[44:47], 0 offen offset:384
    buffer_load_dword v20, v1, s[44:47], 0 offen offset:512
    buffer_load_dword v21, v1, s[44:47], 0 offen offset:640
    buffer_load_dword v22, v1, s[44:47], 0 offen offset:768
    buffer_load_dword v23, v1, s[44:47], 0 offen offset:896
    buffer_load_dword v24, v1, s[44:47], 0 offen offset:1024
    s_and_b32 s35, s29, 3
    s_lshl_b32 s39, s28, 2
    s_add_u32 s39, s39, s35
    s_lshr_b32 s40, s29, 2
    s_cmp_ge_u32 s29, 16
    s_cbranch_scc1 L_np1
    s_mov_b32 s48, s10
    s_mov_b32 s49, s11
    s_mov_b32 s50, 4718592
    s_mov_b32 s51, 0x20000
    v_lshrrev_b32 v2, 4, v0
    v_lshlrev_b32 v2, 13, v2
    v_and_b32 v60, 15, v0
    v_lshl_add_u32 v2, v60, 4, v2
    s_mul_i32 s83, s40, 144
    s_mul_i32 s35, s33, 36
    s_add_u32 s83, s83, s35
    s_lshl_b32 s67, s83, 13
    s_lshl_b32 s35, s39, 8
    s_add_u32 s67, s67, s35
    s_add_u32 s68, s67, 0
    buffer_load_dwordx4 a[0:3], v2, s[48:51], s68 offen nt
    s_add_u32 s68, s67, 32768
    buffer_load_dwordx4 a[4:7], v2, s[48:51], s68 offen nt
    s_add_u32 s68, s67, 65536
    buffer_load_dwordx4 a[8:11], v2, s[48:51], s68 offen nt
    s_add_u32 s68, s67, 98304
    buffer_load_dwordx4 a[12:15], v2, s[48:51], s68 offen nt
    s_add_u32 s68, s67, 131072
    buffer_load_dwordx4 a[16:19], v2, s[48:51], s68 offen nt
    s_add_u32 s68, s67, 163840
    buffer_load_dwordx4 a[20:23], v2, s[48:51], s68 offen nt
    s_add_u32 s68, s67, 196608
    buffer_load_dwordx4 a[24:27], v2, s[48:51], s68 offen nt
    s_add_u32 s68, s67, 229376
    buffer_load_dwordx4 a[28:31], v2, s[48:51], s68 offen nt
    s_add_u32 s68, s67, 262144
    buffer_load_dwordx4 a[32:35], v2, s[48:51], s68 offen nt
L_np1:
    v_mov_b32 v4, 0
    v_mov_b32 v5, 0
    v_mov_b32 v6, 0
    v_mov_b32 v7, 0
    ds_write_b128 v59, v[4:7] offset:9216
    ds_write_b128 v59, v[4:7] offset:9232
    ds_write_b128 v59, v[4:7] offset:9248
    s_mov_b32 s85, 0
    s_waitcnt lgkmcnt(0)
    s_barrier
    v_and_b32 v4, 1, v0
    v_cmp_eq_u32 vcc, 1, v4
    v_mov_b32 v5, 0xffff
    v_mov_b32 v6, 0xffff0000
    v_cndmask_b32 v5, v5, v6, vcc
    v_bfe_u32 v4, v0, 1, 2
    v_cmp_eq_u32 vcc, 0, v4
    s_nop 1
    v_cndmask_b32 v12, 0, v5, vcc
    v_cmp_eq_u32 vcc, 1, v4
    s_nop 1
    v_cndmask_b32 v13, 0, v5, vcc
    v_cmp_eq_u32 vcc, 2, v4
    s_nop 1
    v_cndmask_b32 v14, 0, v5, vcc
    v_cmp_eq_u32 vcc, 3, v4
    s_nop 1
    v_cndmask_b32 v15, 0, v5, vcc
    s_cmp_ge_u32 s29, 16
    s_cbranch_scc1 L_np2
    s_waitcnt vmcnt(9)
    s_branch L_ln
L_np2:
    s_waitcnt vmcnt(0)
L_ln:
    v_readfirstlane_b32 s82, v25
    v_lshlrev_b32 v26, 16, v16
    v_and_b32 v27, 0xffff0000, v16
    v_lshlrev_b32 v28, 16, v17
    v_and_b32 v29, 0xffff0000, v17
    v_lshlrev_b32 v30, 16, v18
    v_and_b32 v31, 0xffff0000, v18
    v_lshlrev_b32 v32, 16, v19
    v_and_b32 v33, 0xffff0000, v19
    v_lshlrev_b32 v34, 16, v20
    v_and_b32 v35, 0xffff0000, v20
    v_lshlrev_b32 v36, 16, v21
    v_and_b32 v37, 0xffff0000, v21
    v_lshlrev_b32 v38, 16, v22
    v_and_b32 v39, 0xffff0000, v22
    v_lshlrev_b32 v40, 16, v23
    v_and_b32 v41, 0xffff0000, v23
    v_lshlrev_b32 v42, 16, v24
    v_and_b32 v43, 0xffff0000, v24
    s_add_u32 s82, s82, 0x9e3779b1
    v_pk_add_f32 v[44:45], v[26:27], v[28:29]
    v_pk_add_f32 v[44:45], v[44:45], v[30:31]
    v_pk_add_f32 v[44:45], v[44:45], v[32:33]
    v_pk_add_f32 v[44:45], v[44:45], v[34:35]
    v_pk_add_f32 v[44:45], v[44:45], v[36:37]
    v_pk_add_f32 v[44:45], v[44:45], v[38:39]
    v_pk_add_f32 v[44:45], v[44:45], v[40:41]
    v_pk_add_f32 v[44:45], v[44:45], v[42:43]
    v_add_f32 v44, v44, v45
    s_nop 1
    v_add_f32_dpp v44, v44, v44 quad_perm:[1,0,3,2] row_mask:0xf bank_mask:0xf
    s_nop 1
    v_add_f32_dpp v44, v44, v44 quad_perm:[2,3,0,1] row_mask:0xf bank_mask:0xf
    s_nop 1
    v_add_f32_dpp v44, v44, v44 row_half_mirror row_mask:0xf bank_mask:0xf
    s_nop 1
    v_add_f32_dpp v44, v44, v44 row_mirror row_mask:0xf bank_mask:0xf
    v_mov_b32 v46, v44
    s_nop 1
    v_permlane16_swap_b32 v44, v46
    s_nop 1
    v_add_f32 v44, v44, v46
    v_mul_f32 v44, 0x3ae38e39, v44
    v_mov_b32 v48, 0
    v_mov_b32 v49, 0
    v_pk_add_f32 v[46:47], v[26:27], v[44:45] op_sel_hi:[1,0] neg_lo:[0,1] neg_hi:[0,1]
    v_pk_fma_f32 v[48:49], v[46:47], v[46:47], v[48:49]
    v_pk_add_f32 v[46:47], v[28:29], v[44:45] op_sel_hi:[1,0] neg_lo:[0,1] neg_hi:[0,1]
    v_pk_fma_f32 v[48:49], v[46:47], v[46:47], v[48:49]
    v_pk_add_f32 v[46:47], v[30:31], v[44:45] op_sel_hi:[1,0] neg_lo:[0,1] neg_hi:[0,1]
    v_pk_fma_f32 v[48:49], v[46:47], v[46:47], v[48:49]
    v_pk_add_f32 v[46:47], v[32:33], v[44:45] op_sel_hi:[1,0] neg_lo:[0,1] neg_hi:[0,1]
    v_pk_fma_f32 v[48:49], v[46:47], v[46:47], v[48:49]
    v_pk_add_f32 v[46:47], v[34:35], v[44:45] op_sel_hi:[1,0] neg_lo:[0,1] neg_hi:[0,1]
    v_pk_fma_f32 v[48:49], v[46:47], v[46:47], v[48:49]
    v_pk_add_f32 v[46:47], v[36:37], v[44:45] op_sel_hi:[1,0] neg_lo:[0,1] neg_hi:[0,1]
    v_pk_fma_f32 v[48:49], v[46:47], v[46:47], v[48:49]
    v_pk_add_f32 v[46:47], v[38:39], v[44:45] op_sel_hi:[1,0] neg_lo:[0,1] neg_hi:[0,1]
    v_pk_fma_f32 v[48:49], v[46:47], v[46:47], v[48:49]
    v_pk_add_f32 v[46:47], v[40:41], v[44:45] op_sel_hi:[1,0] neg_lo:[0,1] neg_hi:[0,1]
    v_pk_fma_f32 v[48:49], v[46:47], v[46:47], v[48:49]
    v_pk_add_f32 v[46:47], v[42:43], v[44:45] op_sel_hi:[1,0] neg_lo:[0,1] neg_hi:[0,1]
    v_pk_fma_f32 v[48:49], v[46:47], v[46:47], v[48:49]
    v_add_f32 v45, v48, v49
    s_nop 1
    v_add_f32_dpp v45, v45, v45 quad_perm:[1,0,3,2] row_mask:0xf bank_mask:0xf
    s_nop 1
    v_add_f32_dpp v45, v45, v45 quad_perm:[2,3,0,1] row_mask:0xf bank_mask:0xf
    s_nop 1
    v_add_f32_dpp v45, v45, v45 row_half_mirror row_mask:0xf bank_mask:0xf
    s_nop 1
    v_add_f32_dpp v45, v45, v45 row_mirror row_mask:0xf bank_mask:0xf
    v_mov_b32 v46, v45
    s_nop 1
    v_permlane16_swap_b32 v45, v46
    s_nop 1
    v_add_f32 v45, v45, v46
    v_mul_f32 v45, 0x3ae38e39, v45
    v_cvt_pk_bf16_f32 v46, v44, v45
    v_lshlrev_b32 v44, 16, v46
    v_and_b32 v45, 0xffff0000, v46
    v_add_f32 v50, 0x3727c5ac, v45
    v_cvt_pk_bf16_f32 v46, v50, v50
    v_and_b32 v50, 0xffff0000, v46
    v_sqrt_f32 v50, v50
    s_nop 0
    v_cvt_pk_bf16_f32 v46, v50, v50
    v_and_b32 v50, 0xffff0000, v46
    v_rcp_f32 v54, v50
    v_lshrrev_b32 v1, 5, v0
    v_mul_u32_u24 v1, 2304, v1
    v_and_b32 v46, 31, v0
    v_lshl_add_u32 v1, v46, 3, v1
    v_pk_add_f32 v[26:27], v[26:27], v[44:45] op_sel_hi:[1,0] neg_lo:[0,1] neg_hi:[0,1]
    v_cvt_pk_bf16_f32 v46, v26, v27
    v_lshlrev_b32 v26, 16, v46
    v_and_b32 v27, 0xffff0000, v46
    v_pk_mul_f32 v[48:49], v[26:27], v[54:55] op_sel_hi:[1,0]
    v_pk_fma_f32 v[52:53], v[48:49], v[50:51], v[26:27] op_sel_hi:[1,0,1] neg_lo:[1,0,0] neg_hi:[1,0,0]
    v_pk_fma_f32 v[48:49], v[52:53], v[54:55], v[48:49] op_sel_hi:[1,0,1]
    v_cvt_pk_bf16_f32 v56, v48, v48
    v_cvt_pk_bf16_f32 v57, v49, v49
    ds_write_b64 v1, v[56:57] offset:0
    v_pk_add_f32 v[28:29], v[28:29], v[44:45] op_sel_hi:[1,0] neg_lo:[0,1] neg_hi:[0,1]
    v_cvt_pk_bf16_f32 v46, v28, v29
    v_lshlrev_b32 v28, 16, v46
    v_and_b32 v29, 0xffff0000, v46
    v_pk_mul_f32 v[48:49], v[28:29], v[54:55] op_sel_hi:[1,0]
    v_pk_fma_f32 v[52:53], v[48:49], v[50:51], v[28:29] op_sel_hi:[1,0,1] neg_lo:[1,0,0] neg_hi:[1,0,0]
    v_pk_fma_f32 v[48:49], v[52:53], v[54:55], v[48:49] op_sel_hi:[1,0,1]
    v_cvt_pk_bf16_f32 v56, v48, v48
    v_cvt_pk_bf16_f32 v57, v49, v49
    ds_write_b64 v1, v[56:57] offset:256
    v_pk_add_f32 v[30:31], v[30:31], v[44:45] op_sel_hi:[1,0] neg_lo:[0,1] neg_hi:[0,1]
    v_cvt_pk_bf16_f32 v46, v30, v31
    v_lshlrev_b32 v30, 16, v46
    v_and_b32 v31, 0xffff0000, v46
    v_pk_mul_f32 v[48:49], v[30:31], v[54:55] op_sel_hi:[1,0]
    v_pk_fma_f32 v[52:53], v[48:49], v[50:51], v[30:31] op_sel_hi:[1,0,1] neg_lo:[1,0,0] neg_hi:[1,0,0]
    v_pk_fma_f32 v[48:49], v[52:53], v[54:55], v[48:49] op_sel_hi:[1,0,1]
    v_cvt_pk_bf16_f32 v56, v48, v48
    v_cvt_pk_bf16_f32 v57, v49, v49
    ds_write_b64 v1, v[56:57] offset:512
    v_pk_add_f32 v[32:33], v[32:33], v[44:45] op_sel_hi:[1,0] neg_lo:[0,1] neg_hi:[0,1]
    v_cvt_pk_bf16_f32 v46, v32, v33
    v_lshlrev_b32 v32, 16, v46
    v_and_b32 v33, 0xffff0000, v46
    v_pk_mul_f32 v[48:49], v[32:33], v[54:55] op_sel_hi:[1,0]
    v_pk_fma_f32 v[52:53], v[48:49], v[50:51], v[32:33] op_sel_hi:[1,0,1] neg_lo:[1,0,0] neg_hi:[1,0,0]
    v_pk_fma_f32 v[48:49], v[52:53], v[54:55], v[48:49] op_sel_hi:[1,0,1]
    v_cvt_pk_bf16_f32 v56, v48, v48
    v_cvt_pk_bf16_f32 v57, v49, v49
    ds_write_b64 v1, v[56:57] offset:768
    v_pk_add_f32 v[34:35], v[34:35], v[44:45] op_sel_hi:[1,0] neg_lo:[0,1] neg_hi:[0,1]
    v_cvt_pk_bf16_f32 v46, v34, v35
    v_lshlrev_b32 v34, 16, v46
    v_and_b32 v35, 0xffff0000, v46
    v_pk_mul_f32 v[48:49], v[34:35], v[54:55] op_sel_hi:[1,0]
    v_pk_fma_f32 v[52:53], v[48:49], v[50:51], v[34:35] op_sel_hi:[1,0,1] neg_lo:[1,0,0] neg_hi:[1,0,0]
    v_pk_fma_f32 v[48:49], v[52:53], v[54:55], v[48:49] op_sel_hi:[1,0,1]
    v_cvt_pk_bf16_f32 v56, v48, v48
    v_cvt_pk_bf16_f32 v57, v49, v49
    ds_write_b64 v1, v[56:57] offset:1024
    v_pk_add_f32 v[36:37], v[36:37], v[44:45] op_sel_hi:[1,0] neg_lo:[0,1] neg_hi:[0,1]
    v_cvt_pk_bf16_f32 v46, v36, v37
    v_lshlrev_b32 v36, 16, v46
    v_and_b32 v37, 0xffff0000, v46
    v_pk_mul_f32 v[48:49], v[36:37], v[54:55] op_sel_hi:[1,0]
    v_pk_fma_f32 v[52:53], v[48:49], v[50:51], v[36:37] op_sel_hi:[1,0,1] neg_lo:[1,0,0] neg_hi:[1,0,0]
    v_pk_fma_f32 v[48:49], v[52:53], v[54:55], v[48:49] op_sel_hi:[1,0,1]
    v_cvt_pk_bf16_f32 v56, v48, v48
    v_cvt_pk_bf16_f32 v57, v49, v49
    ds_write_b64 v1, v[56:57] offset:1280
    v_pk_add_f32 v[38:39], v[38:39], v[44:45] op_sel_hi:[1,0] neg_lo:[0,1] neg_hi:[0,1]
    v_cvt_pk_bf16_f32 v46, v38, v39
    v_lshlrev_b32 v38, 16, v46
    v_and_b32 v39, 0xffff0000, v46
    v_pk_mul_f32 v[48:49], v[38:39], v[54:55] op_sel_hi:[1,0]
    v_pk_fma_f32 v[52:53], v[48:49], v[50:51], v[38:39] op_sel_hi:[1,0,1] neg_lo:[1,0,0] neg_hi:[1,0,0]
    v_pk_fma_f32 v[48:49], v[52:53], v[54:55], v[48:49] op_sel_hi:[1,0,1]
    v_cvt_pk_bf16_f32 v56, v48, v48
    v_cvt_pk_bf16_f32 v57, v49, v49
    ds_write_b64 v1, v[56:57] offset:1536
    v_pk_add_f32 v[40:41], v[40:41], v[44:45] op_sel_hi:[1,0] neg_lo:[0,1] neg_hi:[0,1]
    v_cvt_pk_bf16_f32 v46, v40, v41
    v_lshlrev_b32 v40, 16, v46
    v_and_b32 v41, 0xffff0000, v46
    v_pk_mul_f32 v[48:49], v[40:41], v[54:55] op_sel_hi:[1,0]
    v_pk_fma_f32 v[52:53], v[48:49], v[50:51], v[40:41] op_sel_hi:[1,0,1] neg_lo:[1,0,0] neg_hi:[1,0,0]
    v_pk_fma_f32 v[48:49], v[52:53], v[54:55], v[48:49] op_sel_hi:[1,0,1]
    v_cvt_pk_bf16_f32 v56, v48, v48
    v_cvt_pk_bf16_f32 v57, v49, v49
    ds_write_b64 v1, v[56:57] offset:1792
    v_pk_add_f32 v[42:43], v[42:43], v[44:45] op_sel_hi:[1,0] neg_lo:[0,1] neg_hi:[0,1]
    v_cvt_pk_bf16_f32 v46, v42, v43
    v_lshlrev_b32 v42, 16, v46
    v_and_b32 v43, 0xffff0000, v46
    v_pk_mul_f32 v[48:49], v[42:43], v[54:55] op_sel_hi:[1,0]
    v_pk_fma_f32 v[52:53], v[48:49], v[50:51], v[42:43] op_sel_hi:[1,0,1] neg_lo:[1,0,0] neg_hi:[1,0,0]
    v_pk_fma_f32 v[48:49], v[52:53], v[54:55], v[48:49] op_sel_hi:[1,0,1]
    v_cvt_pk_bf16_f32 v56, v48, v48
    v_cvt_pk_bf16_f32 v57, v49, v49
    ds_write_b64 v1, v[56:57] offset:2048
    v_lshrrev_b32 v62, 5, v0
    v_lshlrev_b32 v62, 9, v62
    v_and_b32 v60, 15, v0
    v_lshl_add_u32 v62, v60, 5, v62
    v_bfe_u32 v60, v0, 4, 1
    v_lshl_add_u32 v62, v60, 4, v62
    s_waitcnt lgkmcnt(0)
    s_cmp_ge_u32 s29, 16
    s_cbranch_scc1 L_qgather
    v_bfe_u32 v1, v0, 3, 1
    v_mul_u32_u24 v1, 2304, v1
    v_lshrrev_b32 v46, 4, v0
    v_lshl_add_u32 v1, v46, 2, v1
    s_lshl_b32 s35, s83, 2
    v_add_u32 v1, s35, v1
    ds_read_b32 v16, v1 offset:0
    ds_read_b32 v17, v1 offset:16
    ds_read_b32 v18, v1 offset:32
    ds_read_b32 v19, v1 offset:48
    ds_read_b32 v20, v1 offset:64
    ds_read_b32 v21, v1 offset:80
    ds_read_b32 v22, v1 offset:96
    ds_read_b32 v23, v1 offset:112
    ds_read_b32 v24, v1 offset:128
    s_waitcnt lgkmcnt(0)
    v_and_b32 v28, v12, v16
    v_and_b32 v29, v13, v16
    v_and_b32 v30, v14, v16
    v_and_b32 v31, v15, v16
    s_waitcnt vmcnt(8)
    s_nop 0
    v_mfma_f32_16x16x32_bf16 v[40:43], v[28:31], a[0:3], 0
    v_and_b32 v32, v12, v17
    v_and_b32 v33, v13, v17
    v_and_b32 v34, v14, v17
    v_and_b32 v35, v15, v17
    s_waitcnt vmcnt(7)
    s_nop 0
    v_mfma_f32_16x16x32_bf16 v[40:43], v[32:35], a[4:7], v[40:43]
    v_and_b32 v28, v12, v18
    v_and_b32 v29, v13, v18
    v_and_b32 v30, v14, v18
    v_and_b32 v31, v15, v18
    s_waitcnt vmcnt(6)
    s_nop 0
    v_mfma_f32_16x16x32_bf16 v[40:43], v[28:31], a[8:11], v[40:43]
    v_and_b32 v32, v12, v19
    v_and_b32 v33, v13, v19
    v_and_b32 v34, v14, v19
    v_and_b32 v35, v15, v19
    s_waitcnt vmcnt(5)
    s_nop 0
    v_mfma_f32_16x16x32_bf16 v[40:43], v[32:35], a[12:15], v[40:43]
    v_and_b32 v28, v12, v20
    v_and_b32 v29, v13, v20
    v_and_b32 v30, v14, v20
    v_and_b32 v31, v15, v20
    s_waitcnt vmcnt(4)
    s_nop 0
    v_mfma_f32_16x16x32_bf16 v[40:43], v[28:31], a[16:19], v[40:43]
    v_and_b32 v32, v12, v21
    v_and_b32 v33, v13, v21
    v_and_b32 v34, v14, v21
    v_and_b32 v35, v15, v21
    s_waitcnt vmcnt(3)
    s_nop 0
    v_mfma_f32_16x16x32_bf16 v[40:43], v[32:35], a[20:23], v[40:43]
    v_and_b32 v28, v12, v22
    v_and_b32 v29, v13, v22
    v_and_b32 v30, v14, v22
    v_and_b32 v31, v15, v22
    s_waitcnt vmcnt(2)
    s_nop 0
    v_mfma_f32_16x16x32_bf16 v[40:43], v[28:31], a[24:27], v[40:43]
    v_and_b32 v32, v12, v23
    v_and_b32 v33, v13, v23
    v_and_b32 v34, v14, v23
    v_and_b32 v35, v15, v23
    s_waitcnt vmcnt(1)
    s_nop 0
    v_mfma_f32_16x16x32_bf16 v[40:43], v[32:35], a[28:31], v[40:43]
    v_and_b32 v28, v12, v24
    v_and_b32 v29, v13, v24
    v_and_b32 v30, v14, v24
    v_and_b32 v31, v15, v24
    s_waitcnt vmcnt(0)
    s_nop 0
    v_mfma_f32_16x16x32_bf16 v[40:43], v[28:31], a[32:35], v[40:43]
    s_lshl_b32 s35, s33, 10
    v_add_u32 v60, s35, v62
    s_nop 7
    ds_write_b128 v60, v[40:43] offset:4608
    s_add_u32 s85, s85, 1
    s_lshl_b32 s35, s33, 2
    v_mov_b32 v8, s35
    v_mov_b32 v9, s85
    v_mov_b32 v10, 0
    s_waitcnt lgkmcnt(0)
    ds_write_b32 v8, v9 offset:9216
L_hsync_14:
    ds_read_b128 v[4:7], v10 offset:9216
    s_waitcnt lgkmcnt(0)
    v_min3_u32 v4, v4, v5, v6
    v_min_u32 v4, v4, v7
    v_cmp_gt_u32 vcc, s85, v4
    s_cbranch_vccnz L_hsync_14
    s_lshl_b32 s35, s33, 8
    v_lshlrev_b32 v21, 2, v0
    v_add_u32 v21, s35, v21
    ds_read_b32 v16, v21 offset:4608
    ds_read_b32 v17, v21 offset:5632
    ds_read_b32 v18, v21 offset:6656
    ds_read_b32 v19, v21 offset:7680
    s_lshl_b32 s35, s39, 2
    s_add_u32 s35, s35, s40
    s_lshl_b32 s35, s35, 11
    s_add_u32 s35, s35, 65536
    v_lshlrev_b32 v21, 1, v21
    v_mov_b32 v23, s82
    s_waitcnt lgkmcnt(0)
    v_add_f32 v16, v16, v17
    v_add_f32 v18, v18, v19
    v_add_f32 v22, v16, v18
    buffer_store_dwordx2 v[22:23], v21, s[60:63], s35 offen sc1
L_qgather:
    s_lshl_b32 s35, s30, 1
    s_lshr_b32 s36, s33, 1
    s_add_u32 s35, s35, s36
    s_lshl_b32 s35, s35, 13
    s_lshl_b32 s36, s31, 10
    s_add_u32 s35, s35, s36
    s_and_b32 s36, s33, 1
    s_lshl_b32 s36, s36, 9
    s_add_u32 s35, s35, s36
    s_add_u32 s35, s35, 65536
    s_add_u32 s36, s35, 4096
    v_lshlrev_b32 v24, 3, v0
    s_mov_b32 s76, 0
L_pollq:
    buffer_load_dwordx2 v[16:17], v24, s[60:63], s35 offen sc1
    buffer_load_dwordx2 v[18:19], v24, s[60:63], s35 offen offset:2048 sc1
    buffer_load_dwordx2 v[20:21], v24, s[60:63], s36 offen sc1
    buffer_load_dwordx2 v[22:23], v24, s[60:63], s36 offen offset:2048 sc1
    s_waitcnt vmcnt(0)
    v_sad_u32 v25, v17, s82, 0
    v_sad_u32 v25, v19, s82, v25
    v_sad_u32 v25, v21, s82, v25
    v_sad_u32 v25, v23, s82, v25
    v_cmp_ne_u32 vcc, 0, v25
    s_cbranch_vccz L_ok_15
    s_add_u32 s76, s76, 1
    s_cmp_lt_u32 s76, 20000
    s_cbranch_scc1 L_pollq
L_ok_15:
    v_add_f32 v16, v16, v18
    v_add_f32 v20, v20, v22
    v_add_f32 v16, v16, v20
    v_cvt_pk_bf16_f32 v16, v16, v16
    s_lshl_b32 s35, s33, 7
    v_lshlrev_b32 v17, 1, v0
    v_add_u32 v17, s35, v17
    ds_write_b16 v17, v16 offset:8704
    v_mov_b32 v18, 0
    v_mov_b32 v19, s82
    ds_write_b32 v18, v19 offset:9252
    s_waitcnt lgkmcnt(0)
    s_barrier
    s_setprio 0
    v_mov_b32 v10, 0
L_wflag_16:
    s_sleep 8
    ds_read_b32 v4, v10 offset:9248
    s_waitcnt lgkmcnt(0)
    v_cmp_eq_u32 vcc, 0, v4
    s_cbranch_vccnz L_wflag_16
    s_branch L_claim_next
L_done:
    s_endpgm
.section .rodata,"a"
.p2align 6
.amdhsa_kernel recurrent_scan__gqa_block_cached__geglu_ffn__decode_kernel
  .amdhsa_next_free_vgpr 256
  .amdhsa_next_free_sgpr 96
  .amdhsa_accum_offset 64
  .amdhsa_group_segment_fixed_size 0
  .amdhsa_kernarg_size 96
  .amdhsa_user_sgpr_count 2
  .amdhsa_user_sgpr_kernarg_segment_ptr 1
  .amdhsa_system_sgpr_workgroup_id_x 1
.end_amdhsa_kernel
```
